```python
import torch

def _softmax(x, axis=-1):
    return torch.softmax(x, dim=axis)
def _gelu(x):
    return torch.nn.functional.gelu(x, approximate="tanh")
def _silu(x):
    return torch.nn.functional.silu(x)
def _sigmoid(x):
    return torch.sigmoid(x)
def _layernorm(x, axis=-1, eps=1e-5):
    m = x.mean(dim=axis, keepdim=True)
    v = x.var(dim=axis, keepdim=True, unbiased=False)
    return (x - m) / torch.sqrt(v + eps)
def _scatter_add(tgt, idx, src, axis=0):
    return tgt.clone().index_add_(axis, idx, src)
def _segment_sum(src, seg, n):
    out = torch.zeros((n,) + src.shape[1:], dtype=src.dtype)
    return out.index_add_(0, seg, src)
def _pad(x, pw):
    flat = tuple(v for pair in reversed(pw) for v in pair)
    return torch.nn.functional.pad(x, flat)

kernel_name = 'sequential_preLN__grouped_kv_mqa__moe_arch_mod__prompt'

def setup_inputs():

    _w = (lambda a: (lambda t: t.to(torch.bfloat16) if t.is_floating_point() else t)(torch.as_tensor(a)))
    def _A_setup():
        B, S, D, H = 1, 2048, 448, 16
        Dh = D // H
        return {
            "x": _w((lambda *s: torch.randn(*s, dtype=torch.bfloat16) * 0.05)(B, S, D)),
            "wq": _w((lambda *s: torch.randn(*s, dtype=torch.bfloat16) * 0.05)(D, H * Dh)),
            "wk": _w((lambda *s: torch.randn(*s, dtype=torch.bfloat16) * 0.05)(D, Dh)),
            "wv": _w((lambda *s: torch.randn(*s, dtype=torch.bfloat16) * 0.05)(D, Dh)),
            "wo": _w((lambda *s: torch.randn(*s, dtype=torch.bfloat16) * 0.05)(H * Dh, D)),
        }
    _A_in = _A_setup()

    def _B_setup():
        B, S, D, F, C = 1, 2048, 448, 1792, 2
        return {
            "x": _w((lambda *s: torch.randn(*s, dtype=torch.bfloat16) * 0.05)(B, S, D)),
            "w_r": _w((lambda *s: torch.randn(*s, dtype=torch.bfloat16) * 0.05)(D)),
            "w_gate": _w((lambda *s: torch.randn(*s, dtype=torch.bfloat16) * 0.05)(D, F)),
            "w_up": _w((lambda *s: torch.randn(*s, dtype=torch.bfloat16) * 0.05)(D, F)),
            "w_down": _w((lambda *s: torch.randn(*s, dtype=torch.bfloat16) * 0.05)(F, D)),
        }
    _B_in = _B_setup()

    return {
        "A_x": _A_in["x"],
        "A_wq": _A_in["wq"],
        "A_wk": _A_in["wk"],
        "A_wv": _A_in["wv"],
        "A_wo": _A_in["wo"],
        "B_x": _B_in["x"],
        "B_w_r": _B_in["w_r"],
        "B_w_gate": _B_in["w_gate"],
        "B_w_up": _B_in["w_up"],
        "B_w_down": _B_in["w_down"],
    }

def reference(A_x, A_wq, A_wk, A_wv, A_wo, B_x, B_w_r, B_w_gate, B_w_up, B_w_down):
    def _A_ref(x, wq, wk, wv, wo):
        B, S, D = x.shape
        H = 16
        Dh = D // H
        q = (lambda x, *d: x.permute(*d))((x @ wq).reshape(B, S, H, Dh), 0, 2, 1, 3)
        k = x @ wk
        v = x @ wv
        scores = torch.einsum("bhqd,bkd->bhqk", q, k) * (Dh ** -0.5)
        p = _softmax(scores, axis=-1)
        o = torch.einsum("bhqk,bkd->bhqd", p, v)
        return (lambda x, *d: x.permute(*d))(o, 0, 2, 1, 3).reshape(B, S, H * Dh) @ wo

    def _B_ref(x, w_r, w_gate, w_up, w_down):
        B, S, D = x.shape
        C = 2
        r = x @ w_r
        idx = torch.argsort(-r, axis=-1)[:, :C]
        idx_e = (lambda x, n, axis: torch.repeat_interleave(x, n, dim=axis))(idx.reshape(B, C, 1), D, axis=2)
        x_sel = (lambda x, i, axis: torch.take_along_dim(x, i, dim=axis))(x, idx_e, axis=1)
        g = _silu(x_sel @ w_gate)
        u = x_sel @ w_up
        y = (g * u) @ w_down
        r_sel = _sigmoid((lambda x, i, axis: torch.take_along_dim(x, i, dim=axis))(r, idx, axis=1))
        y = y * r_sel.reshape(B, C, 1)
        b_off = (torch.arange(B) * S).reshape(B, 1)
        flat_idx = (idx + b_off).reshape(B * C)
        zero = (x * 0.0).reshape(B * S, D)
        upd = _scatter_add(zero, flat_idx, y.reshape(B * C, D), axis=0)
        return x + upd.reshape(B, S, D)

    x = A_x
    h = x + _A_ref(_layernorm(x, axis=-1), A_wq, A_wk, A_wv, A_wo)
    h2 = h + _B_ref(_layernorm(h, axis=-1), B_w_r, B_w_gate, B_w_up, B_w_down)
    return h2
```

```asm
; @launch grid=(256,1,1) block=(256,1,1) lds=140288
.amdgcn_target "amdgcn-amd-amdhsa--gfx950"
.text
.globl sequential_preLN__grouped_kv_mqa__moe_arch_mod__prompt_kernel
.p2align 8
.type sequential_preLN__grouped_kv_mqa__moe_arch_mod__prompt_kernel,@function
sequential_preLN__grouped_kv_mqa__moe_arch_mod__prompt_kernel:
    s_cmp_ge_u32 s2, 256
    s_cbranch_scc1 k2_end
    s_mov_b32 s77, 0
k1_entry:
    s_load_dwordx16 s[40:55], s[0:1], 0
    s_load_dwordx8 s[56:63], s[0:1], 64
    s_load_dwordx2 s[14:15], s[0:1], 96
    s_memrealtime s[80:81]
    v_and_b32 v1, 63, v0
    v_lshrrev_b32 v5, 6, v0
    s_nop 0
    v_readfirstlane_b32 s18, v5
    v_and_b32 v2, 15, v0
    v_bfe_u32 v3, v0, 4, 2
    v_lshrrev_b32 v6, 3, v1
    v_mul_u32_u24 v6, 0x380, v6
    v_and_b32 v7, 7, v1
    v_lshl_add_u32 v6, v7, 4, v6
    v_and_b32 v7, 48, v1
    v_xor_b32 v210, v6, v7
    v_xor_b32 v211, 64, v210
    v_add_u32 v211, 0x1c00, v211
    s_and_b32 s16, s2, 7
    s_bfe_u32 s19, s2, 0x20003
    s_lshl4_add_u32 s16, s19, s16
    s_lshr_b32 s19, s18, 1
    s_lshl3_add_u32 s16, s19, s16
    s_and_b32 s34, s18, 1
    s_lshl1_add_u32 s35, s16, s34
    s_mul_i32 s19, s35, 14336
    s_lshr_b32 s17, s2, 5
    s_lshl_b32 s33, s18, 10
    s_mov_b32 s31, 0x00020000
    s_mul_i32 s27, s18, 14336
    s_add_u32 s3, s27, 82944
    s_mov_b32 m0, s3
    v_accvgpr_write_b32 a204, -1
    v_accvgpr_write_b32 a205, -1
    v_accvgpr_write_b32 a206, -1
    v_accvgpr_write_b32 a207, -1
    s_cmp_eq_u32 s17, 0
    s_cbranch_scc1 k1_kv
    v_and_b32 v7, 16, v1
    v_lshlrev_b32 v7, 1, v7
    v_lshl_or_b32 v7, s34, 6, v7
    v_xor_b32 v212, v6, v7
    s_mul_i32 s32, s18, 7168
    s_lshl_b32 s26, s17, 7
    s_add_u32 s32, s32, s26
    s_sub_u32 s32, s32, 128
    s_mov_b32 s30, 401408
    s_cmp_ge_u32 s2, 228
    s_cselect_b32 s78, 0xff, 0
    s_cmp_lt_u32 s18, 2
    s_cselect_b32 s78, s78, 0
    s_waitcnt lgkmcnt(0)
    s_add_u32 s24, s40, s19
    s_addc_u32 s25, s41, 0
    s_mov_b32 s28, s42
    s_mov_b32 s29, s43
    s_cmp_lg_u32 s78, 0
    s_cbranch_scc1 k1_wo1
k1_wo1r:
    global_load_lds_dwordx4 v210, s[24:25] offset:0
    s_add_u32 m0, s3, 1024
    s_nop 0
    global_load_lds_dwordx4 v211, s[24:25] offset:0
    s_add_u32 m0, s33, 0
    s_nop 0
    buffer_load_dwordx4 v212, s[28:31], s32 offen lds
    s_add_u32 s14, s14, s77
    s_addc_u32 s15, s15, 0
    s_add_u32 m0, s33, 4096
    s_add_u32 s32, s32, 28672
    buffer_load_dwordx4 v212, s[28:31], s32 offen lds
    s_add_u32 m0, s3, 1920
    s_nop 0
    global_load_lds_dwordx4 v210, s[24:25] offset:128
    s_add_u32 m0, s3, 2944
    s_nop 0
    global_load_lds_dwordx4 v211, s[24:25] offset:128
    s_add_u32 m0, s33, 8192
    s_add_u32 s32, s32, 28672
    buffer_load_dwordx4 v212, s[28:31], s32 offen lds
    s_add_u32 m0, s33, 12288
    s_add_u32 s32, s32, 28672
    buffer_load_dwordx4 v212, s[28:31], s32 offen lds
    s_add_u32 m0, s3, 3840
    s_nop 0
    global_load_lds_dwordx4 v210, s[24:25] offset:256
    s_add_u32 m0, s3, 4864
    s_nop 0
    global_load_lds_dwordx4 v211, s[24:25] offset:256
    s_add_u32 m0, s33, 16384
    s_add_u32 s32, s32, 28672
    buffer_load_dwordx4 v212, s[28:31], s32 offen lds
    s_add_u32 m0, s33, 20480
    s_add_u32 s32, s32, 28672
    buffer_load_dwordx4 v212, s[28:31], s32 offen lds
    v_lshrrev_b32 v208, 1, v2
    v_xor_b32 v208, v208, v3
    v_lshlrev_b32 v208, 4, v208
    v_lshl_add_u32 v208, v2, 7, v208
    v_add_u32 v208, s3, v208
    v_xor_b32 v209, 64, v208
    s_and_b32 s19, s2, 7
    s_and_b32 s27, s2, 0xe0
    s_lshl2_add_u32 s27, s19, s27
    s_lshl_b32 s19, s19, 12
    v_lshl_add_u32 v252, v1, 4, s19
    s_bfe_u32 s19, s2, 0x10003
    s_lshl1_add_u32 s19, s18, s19
    s_lshl_b32 s19, s19, 15
    s_add_u32 s19, s19, 12582912
    v_add_u32 v254, s19, v252
    v_add_u32 v252, 12976128, v252
    s_bfe_u32 s19, s2, 0x20003
    s_add_u32 s27, s27, s19
    s_lshl2_add_u32 s19, s27, s18
    s_lshl_b32 s19, s19, 12
    v_lshl_add_u32 v253, v1, 4, s19
    s_lshl2_add_u32 s27, s27, s18
    s_mul_i32 s27, s27, 896
    s_add_u32 s27, s27, 4194304
    s_and_b32 s19, s2, 7
    s_mul_i32 s19, s19, 28
    s_lshr_b32 s26, s2, 3
    s_add_u32 s19, s19, s26
    s_lshl_b32 s19, s19, 5
    s_add_u32 s19, s19, 5110912
    v_lshl_add_u32 v251, v1, 4, s27
    s_mov_b64 exec, 0
    s_mov_b32 exec_hi, 0xff000000
    v_lshl_add_u32 v251, v1, 4, s19
    s_mov_b64 exec, -1
    v_mov_b32 v222, s80
    v_mov_b32 v223, s81
    v_mov_b32 v224, 0
    v_mov_b32 v234, s80
    v_mov_b32 v235, s81
    v_mov_b32 v238, s80
    v_mov_b32 v239, s81
    v_mov_b32 v242, s80
    v_mov_b32 v243, s81
    v_mov_b32 v246, s80
    v_mov_b32 v247, s81
    s_sub_u32 s80, s80, 800
    s_subb_u32 s81, s81, 0
    v_mov_b32 v132, 0x3f803f80
    v_mov_b32 v133, 0x3f803f80
    v_mov_b32 v134, 0x3f803f80
    v_mov_b32 v135, 0x3f803f80
    v_bfe_u32 v6, v1, 2, 2
    v_lshl_add_u32 v6, v3, 3, v6
    v_lshlrev_b32 v6, 7, v6
    v_and_b32 v7, 3, v1
    v_lshl_add_u32 v6, v7, 3, v6
    v_bfe_u32 v7, v1, 3, 2
    v_xor_b32 v7, s18, v7
    v_lshl_add_u32 v4, v7, 5, v6
    v_xor_b32 v5, 32, v4
    v_xor_b32 v6, 64, v4
    v_xor_b32 v7, 0x60, v4
    s_lshl_b32 s19, s35, 15
    v_lshrrev_b32 v136, 3, v2
    v_lshl_add_u32 v136, v136, 14, s19
    v_and_b32 v137, 7, v2
    v_lshl_add_u32 v136, v137, 4, v136
    s_lshl2_add_u32 s19, s17, s18
    s_lshl_b32 s19, s19, 2
    s_sub_u32 s19, s19, 16
    v_add_u32 v137, s19, v3
    s_movk_i32 s26, 147
    s_lshl_b32 s19, s18, 6
    v_lshl_add_u32 v12, v3, 4, s19
    v_xor_b32 v138, 0, v137
    v_mul_u32_u24 v139, s26, v138
    v_lshrrev_b32 v139, 10, v139
    v_mad_i32_i24 v138, v139, -7, v138
    v_lshrrev_b32 v140, 2, v139
    v_lshl_add_u32 v8, v140, 12, v136
    v_and_b32 v140, 3, v139
    v_lshl_add_u32 v8, v140, 7, v8
    v_lshrrev_b32 v140, 1, v138
    v_lshl_add_u32 v8, v140, 9, v8
    v_and_b32 v140, 1, v138
    v_lshl_add_u32 v8, v140, 11, v8
    v_xor_b32 v138, 4, v137
    v_mul_u32_u24 v139, s26, v138
    v_lshrrev_b32 v139, 10, v139
    v_mad_i32_i24 v138, v139, -7, v138
    v_lshrrev_b32 v140, 2, v139
    v_lshl_add_u32 v9, v140, 12, v136
    v_and_b32 v140, 3, v139
    v_lshl_add_u32 v9, v140, 7, v9
    v_lshrrev_b32 v140, 1, v138
    v_lshl_add_u32 v9, v140, 9, v9
    v_and_b32 v140, 1, v138
    v_lshl_add_u32 v9, v140, 11, v9
    v_xor_b32 v138, 8, v137
    v_mul_u32_u24 v139, s26, v138
    v_lshrrev_b32 v139, 10, v139
    v_mad_i32_i24 v138, v139, -7, v138
    v_lshrrev_b32 v140, 2, v139
    v_lshl_add_u32 v10, v140, 12, v136
    v_and_b32 v140, 3, v139
    v_lshl_add_u32 v10, v140, 7, v10
    v_lshrrev_b32 v140, 1, v138
    v_lshl_add_u32 v10, v140, 9, v10
    v_and_b32 v140, 1, v138
    v_lshl_add_u32 v10, v140, 11, v10
    v_xor_b32 v138, 12, v137
    v_mul_u32_u24 v139, s26, v138
    v_lshrrev_b32 v139, 10, v139
    v_mad_i32_i24 v138, v139, -7, v138
    v_lshrrev_b32 v140, 2, v139
    v_lshl_add_u32 v11, v140, 12, v136
    v_and_b32 v140, 3, v139
    v_lshl_add_u32 v11, v140, 7, v11
    v_lshrrev_b32 v140, 1, v138
    v_lshl_add_u32 v11, v140, 9, v11
    v_and_b32 v140, 1, v138
    v_lshl_add_u32 v11, v140, 11, v11
    v_xor_b32 v141, 64, v12
    v_xor_b32 v142, 128, v12
    v_xor_b32 v143, 192, v12
    s_mov_b32 s20, 0x00f0000f
    s_mov_b32 s21, 0xf0000f00
    s_mov_b32 s4, 0x22222222
    s_mov_b32 s5, 0x22222222
    s_mov_b32 s6, 0x44444444
    s_mov_b32 s7, 0x44444444
    s_mov_b32 s12, 0x88888888
    s_mov_b32 s13, 0x88888888
    s_cmp_lg_u32 s78, 0
    s_cbranch_scc1 k1_wo2
k1_wo2r:
    s_waitcnt vmcnt(8)
    s_barrier
    ds_read_b128 v[16:19], v208 offset:0
    ds_read_b64_tr_b16 v[72:73], v4 offset:0
    ds_read_b64_tr_b16 v[74:75], v4 offset:512
    ds_read_b64_tr_b16 v[76:77], v5 offset:0
    ds_read_b64_tr_b16 v[78:79], v5 offset:512
    ds_read_b64_tr_b16 v[80:81], v6 offset:0
    ds_read_b64_tr_b16 v[82:83], v6 offset:512
    ds_read_b64_tr_b16 v[84:85], v7 offset:0
    ds_read_b64_tr_b16 v[86:87], v7 offset:512
    s_waitcnt lgkmcnt(8)
    v_mfma_f32_16x16x32_bf16 v[124:127], v[16:19], v[16:19], 0
    ds_read_b128 v[20:23], v209 offset:0
    ds_read_b64_tr_b16 v[88:89], v4 offset:4096
    v_mfma_f32_16x16x32_bf16 v[120:123], v[132:135], v[16:19], 0
    ds_read_b64_tr_b16 v[90:91], v4 offset:4608
    ds_read_b64_tr_b16 v[92:93], v5 offset:4096
    s_add_u32 m0, s3, 5760
    s_nop 0
    global_load_lds_dwordx4 v210, s[24:25] offset:384
    s_waitcnt lgkmcnt(10)
    v_mfma_f32_16x16x32_bf16 v[128:131], v[72:75], v[132:135], 0
    ds_read_b64_tr_b16 v[94:95], v5 offset:4608
    v_mfma_f32_16x16x32_bf16 v[104:107], v[72:75], v[16:19], 0
    ds_read_b64_tr_b16 v[96:97], v6 offset:4096
    ds_read_b64_tr_b16 v[98:99], v6 offset:4608
    s_waitcnt lgkmcnt(11)
    v_mfma_f32_16x16x32_bf16 v[108:111], v[76:79], v[16:19], 0
    ds_read_b64_tr_b16 v[100:101], v7 offset:4096
    s_add_u32 m0, s3, 6784
    s_nop 0
    global_load_lds_dwordx4 v211, s[24:25] offset:384
    s_waitcnt lgkmcnt(10)
    v_mfma_f32_16x16x32_bf16 v[112:115], v[80:83], v[16:19], 0
    ds_read_b64_tr_b16 v[102:103], v7 offset:4608
    s_waitcnt lgkmcnt(9)
    v_mfma_f32_16x16x32_bf16 v[116:119], v[84:87], v[16:19], 0
    s_waitcnt vmcnt(6)
    s_barrier
    s_waitcnt lgkmcnt(6)
    v_mfma_f32_16x16x32_bf16 v[124:127], v[20:23], v[20:23], v[124:127]
    ds_read_b128 v[24:27], v208 offset:2048
    ds_read_b64_tr_b16 v[72:73], v4 offset:8192
    v_mfma_f32_16x16x32_bf16 v[120:123], v[132:135], v[20:23], v[120:123]
    ds_read_b64_tr_b16 v[74:75], v4 offset:8704
    ds_read_b64_tr_b16 v[76:77], v5 offset:8192
    s_add_u32 m0, s33, 24576
    s_add_u32 s32, s32, 28672
    buffer_load_dwordx4 v212, s[28:31], s32 offen lds
    v_mfma_f32_16x16x32_bf16 v[128:131], v[88:91], v[132:135], v[128:131]
    ds_read_b64_tr_b16 v[78:79], v5 offset:8704
    s_waitcnt lgkmcnt(9)
    v_mfma_f32_16x16x32_bf16 v[104:107], v[88:91], v[20:23], v[104:107]
    ds_read_b64_tr_b16 v[80:81], v6 offset:8192
    ds_read_b64_tr_b16 v[82:83], v6 offset:8704
    v_mfma_f32_16x16x32_bf16 v[108:111], v[92:95], v[20:23], v[108:111]
    ds_read_b64_tr_b16 v[84:85], v7 offset:8192
    s_add_u32 m0, s33, 28672
    s_add_u32 s32, s32, 28672
    buffer_load_dwordx4 v212, s[28:31], s32 offen lds
    s_waitcnt lgkmcnt(8)
    v_mfma_f32_16x16x32_bf16 v[112:115], v[96:99], v[20:23], v[112:115]
    ds_read_b64_tr_b16 v[86:87], v7 offset:8704
    v_mfma_f32_16x16x32_bf16 v[116:119], v[100:103], v[20:23], v[116:119]
    s_waitcnt lgkmcnt(6)
    v_mfma_f32_16x16x32_bf16 v[124:127], v[24:27], v[24:27], v[124:127]
    ds_read_b128 v[28:31], v209 offset:2048
    ds_read_b64_tr_b16 v[88:89], v4 offset:12288
    v_mfma_f32_16x16x32_bf16 v[120:123], v[132:135], v[24:27], v[120:123]
    ds_read_b64_tr_b16 v[90:91], v4 offset:12800
    ds_read_b64_tr_b16 v[92:93], v5 offset:12288
    s_add_u32 m0, s3, 7680
    s_nop 0
    global_load_lds_dwordx4 v210, s[24:25] offset:512
    v_mfma_f32_16x16x32_bf16 v[128:131], v[72:75], v[132:135], v[128:131]
    ds_read_b64_tr_b16 v[94:95], v5 offset:12800
    s_waitcnt lgkmcnt(9)
    v_mfma_f32_16x16x32_bf16 v[104:107], v[72:75], v[24:27], v[104:107]
    ds_read_b64_tr_b16 v[96:97], v6 offset:12288
    ds_read_b64_tr_b16 v[98:99], v6 offset:12800
    v_mfma_f32_16x16x32_bf16 v[108:111], v[76:79], v[24:27], v[108:111]
    ds_read_b64_tr_b16 v[100:101], v7 offset:12288
    s_add_u32 m0, s3, 8704
    s_nop 0
    global_load_lds_dwordx4 v211, s[24:25] offset:512
    s_waitcnt lgkmcnt(8)
    v_mfma_f32_16x16x32_bf16 v[112:115], v[80:83], v[24:27], v[112:115]
    ds_read_b64_tr_b16 v[102:103], v7 offset:12800
    v_mfma_f32_16x16x32_bf16 v[116:119], v[84:87], v[24:27], v[116:119]
    s_waitcnt vmcnt(6)
    s_barrier
    s_waitcnt lgkmcnt(6)
    v_mfma_f32_16x16x32_bf16 v[124:127], v[28:31], v[28:31], v[124:127]
    ds_read_b128 v[32:35], v208 offset:4096
    ds_read_b64_tr_b16 v[72:73], v4 offset:16384
    v_mfma_f32_16x16x32_bf16 v[120:123], v[132:135], v[28:31], v[120:123]
    ds_read_b64_tr_b16 v[74:75], v4 offset:16896
    ds_read_b64_tr_b16 v[76:77], v5 offset:16384
    s_add_u32 m0, s33, 32768
    s_add_u32 s32, s32, 28672
    buffer_load_dwordx4 v212, s[28:31], s32 offen lds
    v_mfma_f32_16x16x32_bf16 v[128:131], v[88:91], v[132:135], v[128:131]
    ds_read_b64_tr_b16 v[78:79], v5 offset:16896
    s_waitcnt lgkmcnt(9)
    v_mfma_f32_16x16x32_bf16 v[104:107], v[88:91], v[28:31], v[104:107]
    ds_read_b64_tr_b16 v[80:81], v6 offset:16384
    ds_read_b64_tr_b16 v[82:83], v6 offset:16896
    v_mfma_f32_16x16x32_bf16 v[108:111], v[92:95], v[28:31], v[108:111]
    ds_read_b64_tr_b16 v[84:85], v7 offset:16384
    s_add_u32 m0, s33, 36864
    s_add_u32 s32, s32, 28672
    buffer_load_dwordx4 v212, s[28:31], s32 offen lds
    s_waitcnt lgkmcnt(8)
    v_mfma_f32_16x16x32_bf16 v[112:115], v[96:99], v[28:31], v[112:115]
    ds_read_b64_tr_b16 v[86:87], v7 offset:16896
    v_mfma_f32_16x16x32_bf16 v[116:119], v[100:103], v[28:31], v[116:119]
    s_waitcnt lgkmcnt(6)
    v_mfma_f32_16x16x32_bf16 v[124:127], v[32:35], v[32:35], v[124:127]
    ds_read_b128 v[36:39], v209 offset:4096
    ds_read_b64_tr_b16 v[88:89], v4 offset:20480
    v_mfma_f32_16x16x32_bf16 v[120:123], v[132:135], v[32:35], v[120:123]
    ds_read_b64_tr_b16 v[90:91], v4 offset:20992
    ds_read_b64_tr_b16 v[92:93], v5 offset:20480
    s_add_u32 m0, s3, 9600
    s_nop 0
    global_load_lds_dwordx4 v210, s[24:25] offset:640
    v_mfma_f32_16x16x32_bf16 v[128:131], v[72:75], v[132:135], v[128:131]
    ds_read_b64_tr_b16 v[94:95], v5 offset:20992
    s_waitcnt lgkmcnt(9)
    v_mfma_f32_16x16x32_bf16 v[104:107], v[72:75], v[32:35], v[104:107]
    ds_read_b64_tr_b16 v[96:97], v6 offset:20480
    ds_read_b64_tr_b16 v[98:99], v6 offset:20992
    v_mfma_f32_16x16x32_bf16 v[108:111], v[76:79], v[32:35], v[108:111]
    ds_read_b64_tr_b16 v[100:101], v7 offset:20480
    s_add_u32 m0, s3, 10624
    s_nop 0
    global_load_lds_dwordx4 v211, s[24:25] offset:640
    s_waitcnt lgkmcnt(8)
    v_mfma_f32_16x16x32_bf16 v[112:115], v[80:83], v[32:35], v[112:115]
    ds_read_b64_tr_b16 v[102:103], v7 offset:20992
    v_mfma_f32_16x16x32_bf16 v[116:119], v[84:87], v[32:35], v[116:119]
    s_waitcnt vmcnt(6)
    s_barrier
    s_waitcnt lgkmcnt(6)
    v_mfma_f32_16x16x32_bf16 v[124:127], v[36:39], v[36:39], v[124:127]
    ds_read_b128 v[40:43], v208 offset:6144
    ds_read_b64_tr_b16 v[72:73], v4 offset:24576
    v_mfma_f32_16x16x32_bf16 v[120:123], v[132:135], v[36:39], v[120:123]
    ds_read_b64_tr_b16 v[74:75], v4 offset:25088
    ds_read_b64_tr_b16 v[76:77], v5 offset:24576
    s_add_u32 m0, s33, 40960
    s_add_u32 s32, s32, 28672
    buffer_load_dwordx4 v212, s[28:31], s32 offen lds
    v_mfma_f32_16x16x32_bf16 v[128:131], v[88:91], v[132:135], v[128:131]
    ds_read_b64_tr_b16 v[78:79], v5 offset:25088
    s_waitcnt lgkmcnt(9)
    v_mfma_f32_16x16x32_bf16 v[104:107], v[88:91], v[36:39], v[104:107]
    ds_read_b64_tr_b16 v[80:81], v6 offset:24576
    ds_read_b64_tr_b16 v[82:83], v6 offset:25088
    v_mfma_f32_16x16x32_bf16 v[108:111], v[92:95], v[36:39], v[108:111]
    ds_read_b64_tr_b16 v[84:85], v7 offset:24576
    s_add_u32 m0, s33, 45056
    s_add_u32 s32, s32, 28672
    buffer_load_dwordx4 v212, s[28:31], s32 offen lds
    s_waitcnt lgkmcnt(8)
    v_mfma_f32_16x16x32_bf16 v[112:115], v[96:99], v[36:39], v[112:115]
    ds_read_b64_tr_b16 v[86:87], v7 offset:25088
    v_mfma_f32_16x16x32_bf16 v[116:119], v[100:103], v[36:39], v[116:119]
    s_waitcnt lgkmcnt(6)
    v_mfma_f32_16x16x32_bf16 v[124:127], v[40:43], v[40:43], v[124:127]
    ds_read_b128 v[44:47], v209 offset:6144
    ds_read_b64_tr_b16 v[88:89], v4 offset:28672
    v_mfma_f32_16x16x32_bf16 v[120:123], v[132:135], v[40:43], v[120:123]
    ds_read_b64_tr_b16 v[90:91], v4 offset:29184
    ds_read_b64_tr_b16 v[92:93], v5 offset:28672
    s_add_u32 m0, s3, 11520
    s_nop 0
    global_load_lds_dwordx4 v210, s[24:25] offset:768
    v_mfma_f32_16x16x32_bf16 v[128:131], v[72:75], v[132:135], v[128:131]
    ds_read_b64_tr_b16 v[94:95], v5 offset:29184
    s_waitcnt lgkmcnt(9)
    v_mfma_f32_16x16x32_bf16 v[104:107], v[72:75], v[40:43], v[104:107]
    ds_read_b64_tr_b16 v[96:97], v6 offset:28672
    ds_read_b64_tr_b16 v[98:99], v6 offset:29184
    v_mfma_f32_16x16x32_bf16 v[108:111], v[76:79], v[40:43], v[108:111]
    ds_read_b64_tr_b16 v[100:101], v7 offset:28672
    s_add_u32 m0, s3, 12544
    s_nop 0
    global_load_lds_dwordx4 v211, s[24:25] offset:768
    s_waitcnt lgkmcnt(8)
    v_mfma_f32_16x16x32_bf16 v[112:115], v[80:83], v[40:43], v[112:115]
    ds_read_b64_tr_b16 v[102:103], v7 offset:29184
    v_mfma_f32_16x16x32_bf16 v[116:119], v[84:87], v[40:43], v[116:119]
    s_add_u32 m0, s33, 49152
    s_add_u32 s32, s32, 28672
    buffer_load_dwordx4 v212, s[28:31], s32 offen lds
    s_add_u32 m0, s33, 53248
    s_add_u32 s32, s32, 28672
    buffer_load_dwordx4 v212, s[28:31], s32 offen lds
    s_sub_u32 s37, s2, 32
    s_cmp_eq_u32 s18, 3
    s_cbranch_scc1 k1_fill
    s_cmp_ge_u32 s37, 196
    s_cbranch_scc1 k1_fill
    s_mov_b32 s36, 0
    s_mul_i32 s37, s37, 3
    s_add_u32 s37, s37, s18
    s_lshl4_add_u32 s79, s37, 13008896
    s_mul_i32 s38, s37, 669
    s_lshr_b32 s38, s38, 17
    s_mul_i32 s19, s38, 196
    s_sub_u32 s37, s37, s19
    s_movk_i32 s26, 2341
    s_movk_i32 s22, 3584
    s_movk_i32 s23, 14336
    s_mov_b32 s39, 5242880
    s_cmp_eq_u32 s38, 1
    s_cselect_b32 s8, s56, s54
    s_cselect_b32 s9, s57, s55
    s_cmp_eq_u32 s38, 2
    s_cselect_b32 s8, s58, s8
    s_cselect_b32 s9, s59, s9
    s_cselect_b32 s26, 9363, s26
    s_cselect_b32 s27, 7, 28
    s_cselect_b32 s22, 896, s22
    s_cselect_b32 s23, 28672, s23
    s_cselect_b32 s39, 8439808, s39
    s_mov_b32 s10, 1605632
    s_mov_b32 s11, 0x00020000
    s_mul_i32 s26, s37, s26
    s_lshr_b32 s26, s26, 16
    s_mul_i32 s27, s26, s27
    s_sub_u32 s27, s37, s27
    s_mul_i32 s19, s38, 7168
    s_add_u32 s39, s39, s19
    s_lshl_b32 s19, s26, 10
    s_add_u32 s39, s39, s19
    s_mul_i32 s19, s27, s23
    s_lshl3_add_u32 s39, s19, s39
    s_mul_i32 s26, s26, s22
    s_lshl_b32 s26, s26, 6
    s_lshl_b32 s27, s27, 7
    s_add_u32 s26, s26, s27
    v_lshrrev_b32 v14, 3, v1
    v_mul_u32_u24 v14, s22, v14
    v_and_b32 v15, 7, v1
    v_lshl_add_u32 v14, v15, 4, v14
    v_and_b32 v15, 16, v1
    v_lshlrev_b32 v15, 1, v15
    v_xor_b32 v14, v14, v15
    v_xor_b32 v15, 64, v14
    s_lshl_b32 s22, s22, 3
    s_lshl_b32 s19, s18, 13
    s_add_u32 m0, s19, 58368
    s_nop 0
    buffer_load_dwordx4 v14, s[8:11], s26 offen lds
    s_add_u32 m0, m0, 1024
    s_add_u32 s26, s26, s22
    buffer_load_dwordx4 v15, s[8:11], s26 offen lds
    s_add_u32 m0, m0, 1024
    s_add_u32 s26, s26, s22
    buffer_load_dwordx4 v14, s[8:11], s26 offen lds
    s_add_u32 m0, m0, 1024
    s_add_u32 s26, s26, s22
    buffer_load_dwordx4 v15, s[8:11], s26 offen lds
    s_add_u32 m0, m0, 1024
    s_add_u32 s26, s26, s22
    buffer_load_dwordx4 v14, s[8:11], s26 offen lds
    s_add_u32 m0, m0, 1024
    s_add_u32 s26, s26, s22
    buffer_load_dwordx4 v15, s[8:11], s26 offen lds
    s_add_u32 m0, m0, 1024
    s_add_u32 s26, s26, s22
    buffer_load_dwordx4 v14, s[8:11], s26 offen lds
    s_add_u32 m0, m0, 1024
    s_add_u32 s26, s26, s22
    buffer_load_dwordx4 v15, s[8:11], s26 offen lds
    s_branch k1_side_done
k1_fill:
    s_mov_b32 s36, 2
    s_mov_b32 s79, 0
    s_cmp_lg_u32 s78, 0
    s_cbranch_scc1 k1_wo3
    s_mov_b32 s23, 0
    s_mov_b32 s39, 0
    s_mov_b64 exec, 0
    global_load_dword v220, v251, s[14:15]
    global_load_dword v220, v251, s[14:15]
    global_load_dword v220, v251, s[14:15]
    global_load_dword v220, v251, s[14:15]
    global_load_dword v220, v251, s[14:15]
    global_load_dword v220, v251, s[14:15]
    global_load_dword v220, v251, s[14:15]
k1_fill7:
    global_load_dword v220, v251, s[14:15]
    s_mov_b64 exec, -1
k1_side_done:
    s_waitcnt vmcnt(16)
    s_barrier
    s_waitcnt lgkmcnt(6)
    v_mfma_f32_16x16x32_bf16 v[124:127], v[44:47], v[44:47], v[124:127]
    ds_read_b128 v[48:51], v208 offset:8192
    ds_read_b64_tr_b16 v[72:73], v4 offset:32768
    v_mfma_f32_16x16x32_bf16 v[120:123], v[132:135], v[44:47], v[120:123]
    ds_read_b64_tr_b16 v[74:75], v4 offset:33280
    ds_read_b64_tr_b16 v[76:77], v5 offset:32768
    v_mfma_f32_16x16x32_bf16 v[128:131], v[88:91], v[132:135], v[128:131]
    ds_read_b64_tr_b16 v[78:79], v5 offset:33280
    s_waitcnt lgkmcnt(9)
    v_mfma_f32_16x16x32_bf16 v[104:107], v[88:91], v[44:47], v[104:107]
    ds_read_b64_tr_b16 v[80:81], v6 offset:32768
    ds_read_b64_tr_b16 v[82:83], v6 offset:33280
    v_mfma_f32_16x16x32_bf16 v[108:111], v[92:95], v[44:47], v[108:111]
    ds_read_b64_tr_b16 v[84:85], v7 offset:32768
    s_waitcnt lgkmcnt(8)
    v_mfma_f32_16x16x32_bf16 v[112:115], v[96:99], v[44:47], v[112:115]
    ds_read_b64_tr_b16 v[86:87], v7 offset:33280
    v_mfma_f32_16x16x32_bf16 v[116:119], v[100:103], v[44:47], v[116:119]
    s_waitcnt lgkmcnt(6)
    v_mfma_f32_16x16x32_bf16 v[124:127], v[48:51], v[48:51], v[124:127]
    ds_read_b128 v[52:55], v209 offset:8192
    ds_read_b64_tr_b16 v[88:89], v4 offset:36864
    v_mfma_f32_16x16x32_bf16 v[120:123], v[132:135], v[48:51], v[120:123]
    ds_read_b64_tr_b16 v[90:91], v4 offset:37376
    ds_read_b64_tr_b16 v[92:93], v5 offset:36864
    v_mfma_f32_16x16x32_bf16 v[128:131], v[72:75], v[132:135], v[128:131]
    ds_read_b64_tr_b16 v[94:95], v5 offset:37376
    s_waitcnt lgkmcnt(9)
    v_mfma_f32_16x16x32_bf16 v[104:107], v[72:75], v[48:51], v[104:107]
    ds_read_b64_tr_b16 v[96:97], v6 offset:36864
    ds_read_b64_tr_b16 v[98:99], v6 offset:37376
    v_mfma_f32_16x16x32_bf16 v[108:111], v[76:79], v[48:51], v[108:111]
    ds_read_b64_tr_b16 v[100:101], v7 offset:36864
    s_waitcnt lgkmcnt(8)
    v_mfma_f32_16x16x32_bf16 v[112:115], v[80:83], v[48:51], v[112:115]
    ds_read_b64_tr_b16 v[102:103], v7 offset:37376
    v_mfma_f32_16x16x32_bf16 v[116:119], v[84:87], v[48:51], v[116:119]
    s_waitcnt vmcnt(12)
    s_barrier
    s_waitcnt lgkmcnt(6)
    v_mfma_f32_16x16x32_bf16 v[124:127], v[52:55], v[52:55], v[124:127]
    ds_read_b128 v[56:59], v208 offset:10240
    ds_read_b64_tr_b16 v[72:73], v4 offset:40960
    v_mfma_f32_16x16x32_bf16 v[120:123], v[132:135], v[52:55], v[120:123]
    ds_read_b64_tr_b16 v[74:75], v4 offset:41472
    ds_read_b64_tr_b16 v[76:77], v5 offset:40960
    v_mfma_f32_16x16x32_bf16 v[128:131], v[88:91], v[132:135], v[128:131]
    ds_read_b64_tr_b16 v[78:79], v5 offset:41472
    s_waitcnt lgkmcnt(9)
    v_mfma_f32_16x16x32_bf16 v[104:107], v[88:91], v[52:55], v[104:107]
    ds_read_b64_tr_b16 v[80:81], v6 offset:40960
    ds_read_b64_tr_b16 v[82:83], v6 offset:41472
    v_mfma_f32_16x16x32_bf16 v[108:111], v[92:95], v[52:55], v[108:111]
    ds_read_b64_tr_b16 v[84:85], v7 offset:40960
    s_waitcnt lgkmcnt(8)
    v_mfma_f32_16x16x32_bf16 v[112:115], v[96:99], v[52:55], v[112:115]
    ds_read_b64_tr_b16 v[86:87], v7 offset:41472
    v_mfma_f32_16x16x32_bf16 v[116:119], v[100:103], v[52:55], v[116:119]
    s_waitcnt lgkmcnt(6)
    v_mfma_f32_16x16x32_bf16 v[124:127], v[56:59], v[56:59], v[124:127]
    ds_read_b128 v[60:63], v209 offset:10240
    ds_read_b64_tr_b16 v[88:89], v4 offset:45056
    v_mfma_f32_16x16x32_bf16 v[120:123], v[132:135], v[56:59], v[120:123]
    ds_read_b64_tr_b16 v[90:91], v4 offset:45568
    ds_read_b64_tr_b16 v[92:93], v5 offset:45056
    v_mfma_f32_16x16x32_bf16 v[128:131], v[72:75], v[132:135], v[128:131]
    ds_read_b64_tr_b16 v[94:95], v5 offset:45568
    s_waitcnt lgkmcnt(9)
    v_mfma_f32_16x16x32_bf16 v[104:107], v[72:75], v[56:59], v[104:107]
    ds_read_b64_tr_b16 v[96:97], v6 offset:45056
    ds_read_b64_tr_b16 v[98:99], v6 offset:45568
    v_mfma_f32_16x16x32_bf16 v[108:111], v[76:79], v[56:59], v[108:111]
    ds_read_b64_tr_b16 v[100:101], v7 offset:45056
    s_waitcnt lgkmcnt(8)
    v_mfma_f32_16x16x32_bf16 v[112:115], v[80:83], v[56:59], v[112:115]
    ds_read_b64_tr_b16 v[102:103], v7 offset:45568
    v_mfma_f32_16x16x32_bf16 v[116:119], v[84:87], v[56:59], v[116:119]
    s_waitcnt vmcnt(8)
    s_barrier
    s_waitcnt lgkmcnt(6)
    v_mfma_f32_16x16x32_bf16 v[124:127], v[60:63], v[60:63], v[124:127]
    ds_read_b128 v[64:67], v208 offset:12288
    ds_read_b64_tr_b16 v[72:73], v4 offset:49152
    v_mfma_f32_16x16x32_bf16 v[120:123], v[132:135], v[60:63], v[120:123]
    ds_read_b64_tr_b16 v[74:75], v4 offset:49664
    ds_read_b64_tr_b16 v[76:77], v5 offset:49152
    v_mfma_f32_16x16x32_bf16 v[128:131], v[88:91], v[132:135], v[128:131]
    ds_read_b64_tr_b16 v[78:79], v5 offset:49664
    s_waitcnt lgkmcnt(9)
    v_mfma_f32_16x16x32_bf16 v[104:107], v[88:91], v[60:63], v[104:107]
    ds_read_b64_tr_b16 v[80:81], v6 offset:49152
    ds_read_b64_tr_b16 v[82:83], v6 offset:49664
    v_mfma_f32_16x16x32_bf16 v[108:111], v[92:95], v[60:63], v[108:111]
    ds_read_b64_tr_b16 v[84:85], v7 offset:49152
    s_waitcnt lgkmcnt(8)
    v_mfma_f32_16x16x32_bf16 v[112:115], v[96:99], v[60:63], v[112:115]
    ds_read_b64_tr_b16 v[86:87], v7 offset:49664
    v_mfma_f32_16x16x32_bf16 v[116:119], v[100:103], v[60:63], v[116:119]
    s_waitcnt lgkmcnt(6)
    v_mfma_f32_16x16x32_bf16 v[124:127], v[64:67], v[64:67], v[124:127]
    ds_read_b128 v[68:71], v209 offset:12288
    ds_read_b64_tr_b16 v[88:89], v4 offset:53248
    v_mfma_f32_16x16x32_bf16 v[120:123], v[132:135], v[64:67], v[120:123]
    ds_read_b64_tr_b16 v[90:91], v4 offset:53760
    ds_read_b64_tr_b16 v[92:93], v5 offset:53248
    v_mfma_f32_16x16x32_bf16 v[128:131], v[72:75], v[132:135], v[128:131]
    ds_read_b64_tr_b16 v[94:95], v5 offset:53760
    s_waitcnt lgkmcnt(9)
    v_mfma_f32_16x16x32_bf16 v[104:107], v[72:75], v[64:67], v[104:107]
    ds_read_b64_tr_b16 v[96:97], v6 offset:53248
    ds_read_b64_tr_b16 v[98:99], v6 offset:53760
    v_mfma_f32_16x16x32_bf16 v[108:111], v[76:79], v[64:67], v[108:111]
    ds_read_b64_tr_b16 v[100:101], v7 offset:53248
    s_waitcnt lgkmcnt(8)
    v_mfma_f32_16x16x32_bf16 v[112:115], v[80:83], v[64:67], v[112:115]
    ds_read_b64_tr_b16 v[102:103], v7 offset:53760
    v_mfma_f32_16x16x32_bf16 v[116:119], v[84:87], v[64:67], v[116:119]
    s_waitcnt lgkmcnt(6)
    v_mfma_f32_16x16x32_bf16 v[124:127], v[68:71], v[68:71], v[124:127]
    v_mfma_f32_16x16x32_bf16 v[120:123], v[132:135], v[68:71], v[120:123]
    v_mfma_f32_16x16x32_bf16 v[128:131], v[88:91], v[132:135], v[128:131]
    s_waitcnt lgkmcnt(4)
    v_mfma_f32_16x16x32_bf16 v[104:107], v[88:91], v[68:71], v[104:107]
    v_mfma_f32_16x16x32_bf16 v[108:111], v[92:95], v[68:71], v[108:111]
    s_nop 4
    ds_write_b128 v12, v[128:131] offset:57344
    s_waitcnt lgkmcnt(1)
    v_mfma_f32_16x16x32_bf16 v[112:115], v[96:99], v[68:71], v[112:115]
    v_mfma_f32_16x16x32_bf16 v[116:119], v[100:103], v[68:71], v[116:119]
    v_cndmask_b32 v124, v124, v125, s[4:5]
    v_cndmask_b32 v126, v126, v127, s[12:13]
    v_mul_f32 v120, 0x3b124925, v120
    s_or_b64 s[6:7], s[6:7], s[12:13]
    v_cndmask_b32 v124, v124, v126, s[6:7]
    v_cndmask_b32 v124, 0, v124, s[20:21]
    v_cvt_pk_bf16_f32 v14, v120, v120
    s_waitcnt lgkmcnt(0)
    s_barrier
    ds_read_b128 v[72:75], v12 offset:57344
    ds_read_b128 v[76:79], v141 offset:57344
    ds_read_b128 v[80:83], v142 offset:57344
    ds_read_b128 v[84:87], v143 offset:57344
    v_mov_b32 v15, v124
    s_nop 1
    v_permlane16_swap_b32 v124, v15
    v_add_f32 v124, v124, v15
    v_mul_f32 v120, v120, v120
    v_mov_b32 v15, v124
    s_nop 1
    v_permlane32_swap_b32 v124, v15
    v_add_f32 v124, v124, v15
    s_mov_b32 s26, 0x3b124925
    v_lshlrev_b32 v14, 16, v14
    v_fma_f32 v15, v124, s26, -v120
    v_max_f32 v15, 0, v15
    v_cvt_pk_bf16_f32 v15, v15, v15
    v_lshlrev_b32 v15, 16, v15
    v_add_f32 v15, 0x3727c5ac, v15
    v_cvt_pk_bf16_f32 v15, v15, v15
    v_lshlrev_b32 v15, 16, v15
    v_sqrt_f32 v15, v15
    s_nop 0
    v_cvt_pk_bf16_f32 v15, v15, v15
    v_lshlrev_b32 v15, 16, v15
    v_rcp_f32 v15, v15
    s_waitcnt lgkmcnt(0)
    v_fma_f32 v104, -v14, v72, v104
    v_fma_f32 v105, -v14, v73, v105
    v_fma_f32 v106, -v14, v74, v106
    v_fma_f32 v107, -v14, v75, v107
    v_mul_f32 v120, 0x3b8b9881, v15
    v_fma_f32 v108, -v14, v76, v108
    v_fma_f32 v109, -v14, v77, v109
    v_fma_f32 v110, -v14, v78, v110
    v_fma_f32 v111, -v14, v79, v111
    v_fma_f32 v112, -v14, v80, v112
    v_fma_f32 v113, -v14, v81, v113
    v_fma_f32 v114, -v14, v82, v114
    v_fma_f32 v115, -v14, v83, v115
    v_fma_f32 v116, -v14, v84, v116
    v_fma_f32 v117, -v14, v85, v117
    v_fma_f32 v118, -v14, v86, v118
    v_fma_f32 v119, -v14, v87, v119
    v_pk_mul_f32 v[104:105], v[104:105], v[120:121] op_sel_hi:[1,0]
    v_pk_mul_f32 v[106:107], v[106:107], v[120:121] op_sel_hi:[1,0]
    v_cvt_pk_bf16_f32 v232, v104, v105
    v_cvt_pk_bf16_f32 v233, v106, v107
    global_store_dwordx4 v8, v[232:235], s[14:15] sc1
    v_pk_mul_f32 v[108:109], v[108:109], v[120:121] op_sel_hi:[1,0]
    v_pk_mul_f32 v[110:111], v[110:111], v[120:121] op_sel_hi:[1,0]
    v_cvt_pk_bf16_f32 v236, v108, v109
    v_cvt_pk_bf16_f32 v237, v110, v111
    global_store_dwordx4 v9, v[236:239], s[14:15] sc1
    v_pk_mul_f32 v[112:113], v[112:113], v[120:121] op_sel_hi:[1,0]
    v_pk_mul_f32 v[114:115], v[114:115], v[120:121] op_sel_hi:[1,0]
    v_cvt_pk_bf16_f32 v240, v112, v113
    v_cvt_pk_bf16_f32 v241, v114, v115
    global_store_dwordx4 v10, v[240:243], s[14:15] sc1
    v_pk_mul_f32 v[116:117], v[116:117], v[120:121] op_sel_hi:[1,0]
    v_pk_mul_f32 v[118:119], v[118:119], v[120:121] op_sel_hi:[1,0]
    v_cvt_pk_bf16_f32 v244, v116, v117
    v_cvt_pk_bf16_f32 v245, v118, v119
    global_store_dwordx4 v11, v[244:247], s[14:15] sc1
    s_lshl_b32 s19, s18, 13
    s_add_u32 s19, s19, 58368
    v_add_u32 v4, s19, v4
    v_add_u32 v5, s19, v5
    v_add_u32 v6, s19, v6
    v_add_u32 v7, s19, v7
    v_lshrrev_b32 v14, 3, v2
    v_mul_u32_u24 v14, s23, v14
    v_lshl_add_u32 v14, v3, 7, v14
    v_and_b32 v15, 7, v2
    v_lshl_add_u32 v255, v15, 4, v14
    s_lshl_b32 s23, s23, 1
    s_mov_b32 exec_lo, s78
    s_mov_b32 exec_hi, 0
    s_waitcnt vmcnt(4)
    global_store_dwordx2 v224, v[222:223], s[14:15] sc1
    s_mov_b64 exec, -1
    s_cmp_eq_u32 s36, 2
    s_cbranch_scc1 k1_fin
    ds_read_b64_tr_b16 a[208:209], v4 offset:0
    ds_read_b64_tr_b16 a[210:211], v4 offset:512
    ds_read_b64_tr_b16 a[212:213], v4 offset:4096
    ds_read_b64_tr_b16 a[214:215], v4 offset:4608
    ds_read_b64_tr_b16 a[216:217], v5 offset:0
    ds_read_b64_tr_b16 a[218:219], v5 offset:512
    ds_read_b64_tr_b16 a[220:221], v5 offset:4096
    ds_read_b64_tr_b16 a[222:223], v5 offset:4608
    ds_read_b64_tr_b16 a[224:225], v6 offset:0
    ds_read_b64_tr_b16 a[226:227], v6 offset:512
    ds_read_b64_tr_b16 a[228:229], v6 offset:4096
    ds_read_b64_tr_b16 a[230:231], v6 offset:4608
    ds_read_b64_tr_b16 a[232:233], v7 offset:0
    ds_read_b64_tr_b16 a[234:235], v7 offset:512
    ds_read_b64_tr_b16 a[236:237], v7 offset:4096
    ds_read_b64_tr_b16 a[238:239], v7 offset:4608
k1_fin:
    s_xor_b32 s19, s18, 0
    s_mul_i32 s19, s19, s23
    s_add_u32 s68, s19, s39
    s_xor_b32 s19, s18, 1
    s_mul_i32 s19, s19, s23
    s_add_u32 s69, s19, s39
    s_xor_b32 s19, s18, 2
    s_mul_i32 s19, s19, s23
    s_add_u32 s70, s19, s39
    s_xor_b32 s19, s18, 3
    s_mul_i32 s19, s19, s23
    s_add_u32 s71, s19, s39
    s_cmp_eq_u32 s36, 2
    s_cselect_b64 s[66:67], 0, -1
    s_branch k2_start
k1_kv:
    v_lshlrev_b32 v212, 4, v1
    s_lshl_b32 s32, s34, 10
    s_lshr_b32 s26, s18, 1
    s_mul_i32 s33, s26, 26624
    s_add_u32 s33, s33, s32
    s_movk_i32 s30, 25088
    s_lshl_b32 s27, s35, 11
    s_add_u32 s27, s27, 12582912
    v_add_u32 v220, s27, v212
    s_cmp_eq_u32 s26, 0
    s_waitcnt lgkmcnt(0)
    s_cselect_b32 s28, s44, s46
    s_cselect_b32 s29, s45, s47
    s_add_u32 s24, s40, s19
    s_addc_u32 s25, s41, 0
    global_load_lds_dwordx4 v210, s[24:25] offset:0
    s_add_u32 m0, s3, 1024
    s_nop 0
    global_load_lds_dwordx4 v211, s[24:25] offset:0
    s_add_u32 m0, s33, 0
    s_nop 0
    buffer_load_dwordx4 v212, s[28:31], s32 offen lds
    s_add_u32 s14, s14, s77
    s_addc_u32 s15, s15, 0
    s_add_u32 m0, s33, 2048
    s_add_u32 s32, s32, 2048
    buffer_load_dwordx4 v212, s[28:31], s32 offen lds
    global_store_dwordx4 v220, a[204:207], s[14:15] offset:0 sc1
    global_store_dwordx4 v220, a[204:207], s[14:15] offset:1024 sc1
    s_add_u32 m0, s3, 1920
    s_nop 0
    global_load_lds_dwordx4 v210, s[24:25] offset:128
    s_add_u32 m0, s3, 2944
    s_nop 0
    global_load_lds_dwordx4 v211, s[24:25] offset:128
    s_add_u32 m0, s33, 4096
    s_add_u32 s32, s32, 2048
    buffer_load_dwordx4 v212, s[28:31], s32 offen lds
    s_add_u32 m0, s33, 6144
    s_add_u32 s32, s32, 2048
    buffer_load_dwordx4 v212, s[28:31], s32 offen lds
    s_add_u32 m0, s3, 3840
    s_nop 0
    global_load_lds_dwordx4 v210, s[24:25] offset:256
    s_add_u32 m0, s3, 4864
    s_nop 0
    global_load_lds_dwordx4 v211, s[24:25] offset:256
    s_add_u32 m0, s33, 8192
    s_add_u32 s32, s32, 2048
    buffer_load_dwordx4 v212, s[28:31], s32 offen lds
    s_add_u32 m0, s33, 10240
    s_add_u32 s32, s32, 2048
    buffer_load_dwordx4 v212, s[28:31], s32 offen lds
    v_lshrrev_b32 v208, 1, v2
    v_xor_b32 v208, v208, v3
    v_lshlrev_b32 v208, 4, v208
    v_lshl_add_u32 v208, v2, 7, v208
    v_add_u32 v208, s3, v208
    v_xor_b32 v209, 64, v208
    s_and_b32 s19, s2, 7
    s_and_b32 s27, s2, 0xe0
    s_lshl2_add_u32 s27, s19, s27
    s_lshl_b32 s19, s19, 12
    v_lshl_add_u32 v252, v1, 4, s19
    s_bfe_u32 s19, s2, 0x10003
    s_lshl1_add_u32 s19, s18, s19
    s_lshl_b32 s19, s19, 15
    s_add_u32 s19, s19, 12582912
    v_add_u32 v254, s19, v252
    v_add_u32 v252, 12976128, v252
    s_bfe_u32 s19, s2, 0x20003
    s_add_u32 s27, s27, s19
    s_lshl2_add_u32 s19, s27, s18
    s_lshl_b32 s19, s19, 12
    v_lshl_add_u32 v253, v1, 4, s19
    s_lshl2_add_u32 s27, s27, s18
    s_mul_i32 s27, s27, 896
    s_add_u32 s27, s27, 4194304
    s_and_b32 s19, s2, 7
    s_mul_i32 s19, s19, 28
    s_lshr_b32 s26, s2, 3
    s_add_u32 s19, s19, s26
    s_lshl_b32 s19, s19, 5
    s_add_u32 s19, s19, 5110912
    v_lshl_add_u32 v251, v1, 4, s27
    s_mov_b64 exec, 0
    s_mov_b32 exec_hi, 0xff000000
    v_lshl_add_u32 v251, v1, 4, s19
    s_mov_b64 exec, -1
    v_mov_b32 v222, s80
    v_mov_b32 v223, s81
    v_mov_b32 v224, 0
    s_sub_u32 s80, s80, 800
    s_subb_u32 s81, s81, 0
    v_mov_b32 v132, 0x3f803f80
    v_mov_b32 v133, 0x3f803f80
    v_mov_b32 v134, 0x3f803f80
    v_mov_b32 v135, 0x3f803f80
    v_bfe_u32 v6, v1, 2, 2
    v_lshl_add_u32 v6, v3, 3, v6
    v_mul_u32_u24 v6, 56, v6
    v_and_b32 v7, 3, v1
    v_lshl_add_u32 v14, v7, 3, v6
    v_lshl_add_u32 v4, v7, 4, v6
    v_add_u32 v5, 8, v4
    v_add_u32 v6, 0x6800, v14
    v_add_u32 v7, 0x6820, v14
    s_cmp_eq_u32 s34, 1
    s_cselect_b64 vcc, -1, 0
    v_cndmask_b32 v14, v4, v5, vcc
    v_cndmask_b32 v15, v6, v7, vcc
    s_cmp_ge_u32 s18, 2
    s_cselect_b64 vcc, -1, 0
    v_cndmask_b32 v8, v14, v15, vcc
    s_lshl_b32 s19, s18, 6
    v_lshl_add_u32 v12, v3, 4, s19
    s_mov_b32 s20, 0x00f0000f
    s_mov_b32 s21, 0xf0000f00
    s_mov_b32 s4, 0x22222222
    s_mov_b32 s5, 0x22222222
    s_mov_b32 s6, 0x44444444
    s_mov_b32 s7, 0x44444444
    s_mov_b32 s12, 0x88888888
    s_mov_b32 s13, 0x88888888
    s_waitcnt vmcnt(10)
    s_barrier
    ds_read_b128 v[16:19], v208 offset:0
    ds_read_b64_tr_b16 v[136:137], v8 offset:0
    ds_read_b64_tr_b16 v[138:139], v8 offset:224
    ds_read_b64_tr_b16 v[72:73], v4 offset:0
    ds_read_b64_tr_b16 v[74:75], v4 offset:224
    ds_read_b64_tr_b16 v[76:77], v5 offset:0
    ds_read_b64_tr_b16 v[78:79], v5 offset:224
    ds_read_b64_tr_b16 v[80:81], v6 offset:0
    ds_read_b64_tr_b16 v[82:83], v6 offset:224
    ds_read_b64_tr_b16 v[84:85], v7 offset:0
    ds_read_b64_tr_b16 v[86:87], v7 offset:224
    s_waitcnt lgkmcnt(10)
    v_mfma_f32_16x16x32_bf16 v[124:127], v[16:19], v[16:19], 0
    ds_read_b128 v[20:23], v209 offset:0
    ds_read_b64_tr_b16 v[140:141], v8 offset:1792
    v_mfma_f32_16x16x32_bf16 v[120:123], v[132:135], v[16:19], 0
    ds_read_b64_tr_b16 v[142:143], v8 offset:2016
    ds_read_b64_tr_b16 v[88:89], v4 offset:1792
    s_add_u32 m0, s3, 5760
    s_nop 0
    global_load_lds_dwordx4 v210, s[24:25] offset:384
    s_waitcnt lgkmcnt(12)
    v_mfma_f32_16x16x32_bf16 v[128:131], v[136:139], v[132:135], 0
    ds_read_b64_tr_b16 v[90:91], v4 offset:2016
    ds_read_b64_tr_b16 v[92:93], v5 offset:1792
    s_waitcnt lgkmcnt(12)
    v_mfma_f32_16x16x32_bf16 v[104:107], v[72:75], v[16:19], 0
    ds_read_b64_tr_b16 v[94:95], v5 offset:2016
    ds_read_b64_tr_b16 v[96:97], v6 offset:1792
    s_waitcnt lgkmcnt(12)
    v_mfma_f32_16x16x32_bf16 v[108:111], v[76:79], v[16:19], 0
    ds_read_b64_tr_b16 v[98:99], v6 offset:2016
    s_add_u32 m0, s3, 6784
    s_nop 0
    global_load_lds_dwordx4 v211, s[24:25] offset:384
    s_waitcnt lgkmcnt(11)
    v_mfma_f32_16x16x32_bf16 v[112:115], v[16:19], v[80:83], 0
    ds_read_b64_tr_b16 v[100:101], v7 offset:1792
    ds_read_b64_tr_b16 v[102:103], v7 offset:2016
    s_waitcnt lgkmcnt(11)
    v_mfma_f32_16x16x32_bf16 v[116:119], v[16:19], v[84:87], 0
    s_waitcnt vmcnt(6)
    s_barrier
    s_memrealtime s[96:97]
    s_waitcnt lgkmcnt(8)
    v_mfma_f32_16x16x32_bf16 v[124:127], v[20:23], v[20:23], v[124:127]
    ds_read_b128 v[24:27], v208 offset:2048
    ds_read_b64_tr_b16 v[136:137], v8 offset:3584
    v_mfma_f32_16x16x32_bf16 v[120:123], v[132:135], v[20:23], v[120:123]
    ds_read_b64_tr_b16 v[138:139], v8 offset:3808
    ds_read_b64_tr_b16 v[72:73], v4 offset:3584
    s_add_u32 m0, s33, 12288
    s_add_u32 s32, s32, 2048
    buffer_load_dwordx4 v212, s[28:31], s32 offen lds
    v_mfma_f32_16x16x32_bf16 v[128:131], v[140:143], v[132:135], v[128:131]
    ds_read_b64_tr_b16 v[74:75], v4 offset:3808
    ds_read_b64_tr_b16 v[76:77], v5 offset:3584
    s_waitcnt lgkmcnt(10)
    v_mfma_f32_16x16x32_bf16 v[104:107], v[88:91], v[20:23], v[104:107]
    ds_read_b64_tr_b16 v[78:79], v5 offset:3808
    ds_read_b64_tr_b16 v[80:81], v6 offset:3584
    v_mfma_f32_16x16x32_bf16 v[108:111], v[92:95], v[20:23], v[108:111]
    ds_read_b64_tr_b16 v[82:83], v6 offset:3808
    s_add_u32 m0, s33, 14336
    s_add_u32 s32, s32, 2048
    buffer_load_dwordx4 v212, s[28:31], s32 offen lds
    s_waitcnt lgkmcnt(9)
    v_mfma_f32_16x16x32_bf16 v[112:115], v[20:23], v[96:99], v[112:115]
    ds_read_b64_tr_b16 v[84:85], v7 offset:3584
    ds_read_b64_tr_b16 v[86:87], v7 offset:3808
    v_mfma_f32_16x16x32_bf16 v[116:119], v[20:23], v[100:103], v[116:119]
    s_waitcnt lgkmcnt(8)
    v_mfma_f32_16x16x32_bf16 v[124:127], v[24:27], v[24:27], v[124:127]
    ds_read_b128 v[28:31], v209 offset:2048
    ds_read_b64_tr_b16 v[140:141], v8 offset:5376
    v_mfma_f32_16x16x32_bf16 v[120:123], v[132:135], v[24:27], v[120:123]
    ds_read_b64_tr_b16 v[142:143], v8 offset:5600
    ds_read_b64_tr_b16 v[88:89], v4 offset:5376
    s_add_u32 m0, s3, 7680
    s_nop 0
    global_load_lds_dwordx4 v210, s[24:25] offset:512
    v_mfma_f32_16x16x32_bf16 v[128:131], v[136:139], v[132:135], v[128:131]
    ds_read_b64_tr_b16 v[90:91], v4 offset:5600
    ds_read_b64_tr_b16 v[92:93], v5 offset:5376
    s_waitcnt lgkmcnt(10)
    v_mfma_f32_16x16x32_bf16 v[104:107], v[72:75], v[24:27], v[104:107]
    ds_read_b64_tr_b16 v[94:95], v5 offset:5600
    ds_read_b64_tr_b16 v[96:97], v6 offset:5376
    v_mfma_f32_16x16x32_bf16 v[108:111], v[76:79], v[24:27], v[108:111]
    ds_read_b64_tr_b16 v[98:99], v6 offset:5600
    s_add_u32 m0, s3, 8704
    s_nop 0
    global_load_lds_dwordx4 v211, s[24:25] offset:512
    s_waitcnt lgkmcnt(9)
    v_mfma_f32_16x16x32_bf16 v[112:115], v[24:27], v[80:83], v[112:115]
    ds_read_b64_tr_b16 v[100:101], v7 offset:5376
    ds_read_b64_tr_b16 v[102:103], v7 offset:5600
    v_mfma_f32_16x16x32_bf16 v[116:119], v[24:27], v[84:87], v[116:119]
    s_waitcnt vmcnt(6)
    s_barrier
    s_waitcnt lgkmcnt(8)
    v_mfma_f32_16x16x32_bf16 v[124:127], v[28:31], v[28:31], v[124:127]
    ds_read_b128 v[32:35], v208 offset:4096
    ds_read_b64_tr_b16 v[136:137], v8 offset:7168
    v_mfma_f32_16x16x32_bf16 v[120:123], v[132:135], v[28:31], v[120:123]
    ds_read_b64_tr_b16 v[138:139], v8 offset:7392
    ds_read_b64_tr_b16 v[72:73], v4 offset:7168
    s_add_u32 m0, s33, 16384
    s_add_u32 s32, s32, 2048
    buffer_load_dwordx4 v212, s[28:31], s32 offen lds
    v_mfma_f32_16x16x32_bf16 v[128:131], v[140:143], v[132:135], v[128:131]
    ds_read_b64_tr_b16 v[74:75], v4 offset:7392
    ds_read_b64_tr_b16 v[76:77], v5 offset:7168
    s_waitcnt lgkmcnt(10)
    v_mfma_f32_16x16x32_bf16 v[104:107], v[88:91], v[28:31], v[104:107]
    ds_read_b64_tr_b16 v[78:79], v5 offset:7392
    ds_read_b64_tr_b16 v[80:81], v6 offset:7168
    v_mfma_f32_16x16x32_bf16 v[108:111], v[92:95], v[28:31], v[108:111]
    ds_read_b64_tr_b16 v[82:83], v6 offset:7392
    s_add_u32 m0, s33, 18432
    s_add_u32 s32, s32, 2048
    buffer_load_dwordx4 v212, s[28:31], s32 offen lds
    s_waitcnt lgkmcnt(9)
    v_mfma_f32_16x16x32_bf16 v[112:115], v[28:31], v[96:99], v[112:115]
    ds_read_b64_tr_b16 v[84:85], v7 offset:7168
    ds_read_b64_tr_b16 v[86:87], v7 offset:7392
    v_mfma_f32_16x16x32_bf16 v[116:119], v[28:31], v[100:103], v[116:119]
    s_waitcnt lgkmcnt(8)
    v_mfma_f32_16x16x32_bf16 v[124:127], v[32:35], v[32:35], v[124:127]
    ds_read_b128 v[36:39], v209 offset:4096
    ds_read_b64_tr_b16 v[140:141], v8 offset:8960
    v_mfma_f32_16x16x32_bf16 v[120:123], v[132:135], v[32:35], v[120:123]
    ds_read_b64_tr_b16 v[142:143], v8 offset:9184
    ds_read_b64_tr_b16 v[88:89], v4 offset:8960
    s_add_u32 m0, s3, 9600
    s_nop 0
    global_load_lds_dwordx4 v210, s[24:25] offset:640
    v_mfma_f32_16x16x32_bf16 v[128:131], v[136:139], v[132:135], v[128:131]
    ds_read_b64_tr_b16 v[90:91], v4 offset:9184
    ds_read_b64_tr_b16 v[92:93], v5 offset:8960
    s_waitcnt lgkmcnt(10)
    v_mfma_f32_16x16x32_bf16 v[104:107], v[72:75], v[32:35], v[104:107]
    ds_read_b64_tr_b16 v[94:95], v5 offset:9184
    ds_read_b64_tr_b16 v[96:97], v6 offset:8960
    v_mfma_f32_16x16x32_bf16 v[108:111], v[76:79], v[32:35], v[108:111]
    ds_read_b64_tr_b16 v[98:99], v6 offset:9184
    s_add_u32 m0, s3, 10624
    s_nop 0
    global_load_lds_dwordx4 v211, s[24:25] offset:640
    s_waitcnt lgkmcnt(9)
    v_mfma_f32_16x16x32_bf16 v[112:115], v[32:35], v[80:83], v[112:115]
    ds_read_b64_tr_b16 v[100:101], v7 offset:8960
    ds_read_b64_tr_b16 v[102:103], v7 offset:9184
    v_mfma_f32_16x16x32_bf16 v[116:119], v[32:35], v[84:87], v[116:119]
    s_waitcnt vmcnt(6)
    s_barrier
    s_waitcnt lgkmcnt(8)
    v_mfma_f32_16x16x32_bf16 v[124:127], v[36:39], v[36:39], v[124:127]
    ds_read_b128 v[40:43], v208 offset:6144
    ds_read_b64_tr_b16 v[136:137], v8 offset:10752
    v_mfma_f32_16x16x32_bf16 v[120:123], v[132:135], v[36:39], v[120:123]
    ds_read_b64_tr_b16 v[138:139], v8 offset:10976
    ds_read_b64_tr_b16 v[72:73], v4 offset:10752
    s_add_u32 m0, s33, 20480
    s_add_u32 s32, s32, 2048
    buffer_load_dwordx4 v212, s[28:31], s32 offen lds
    v_mfma_f32_16x16x32_bf16 v[128:131], v[140:143], v[132:135], v[128:131]
    ds_read_b64_tr_b16 v[74:75], v4 offset:10976
    ds_read_b64_tr_b16 v[76:77], v5 offset:10752
    s_waitcnt lgkmcnt(10)
    v_mfma_f32_16x16x32_bf16 v[104:107], v[88:91], v[36:39], v[104:107]
    ds_read_b64_tr_b16 v[78:79], v5 offset:10976
    ds_read_b64_tr_b16 v[80:81], v6 offset:10752
    v_mfma_f32_16x16x32_bf16 v[108:111], v[92:95], v[36:39], v[108:111]
    ds_read_b64_tr_b16 v[82:83], v6 offset:10976
    s_add_u32 m0, s33, 22528
    s_add_u32 s32, s32, 2048
    buffer_load_dwordx4 v212, s[28:31], s32 offen lds
    s_waitcnt lgkmcnt(9)
    v_mfma_f32_16x16x32_bf16 v[112:115], v[36:39], v[96:99], v[112:115]
    ds_read_b64_tr_b16 v[84:85], v7 offset:10752
    ds_read_b64_tr_b16 v[86:87], v7 offset:10976
    v_mfma_f32_16x16x32_bf16 v[116:119], v[36:39], v[100:103], v[116:119]
    s_waitcnt lgkmcnt(8)
    v_mfma_f32_16x16x32_bf16 v[124:127], v[40:43], v[40:43], v[124:127]
    ds_read_b128 v[44:47], v209 offset:6144
    ds_read_b64_tr_b16 v[140:141], v8 offset:12544
    v_mfma_f32_16x16x32_bf16 v[120:123], v[132:135], v[40:43], v[120:123]
    ds_read_b64_tr_b16 v[142:143], v8 offset:12768
    ds_read_b64_tr_b16 v[88:89], v4 offset:12544
    s_add_u32 m0, s3, 11520
    s_nop 0
    global_load_lds_dwordx4 v210, s[24:25] offset:768
    v_mfma_f32_16x16x32_bf16 v[128:131], v[136:139], v[132:135], v[128:131]
    ds_read_b64_tr_b16 v[90:91], v4 offset:12768
    ds_read_b64_tr_b16 v[92:93], v5 offset:12544
    s_waitcnt lgkmcnt(10)
    v_mfma_f32_16x16x32_bf16 v[104:107], v[72:75], v[40:43], v[104:107]
    ds_read_b64_tr_b16 v[94:95], v5 offset:12768
    ds_read_b64_tr_b16 v[96:97], v6 offset:12544
    v_mfma_f32_16x16x32_bf16 v[108:111], v[76:79], v[40:43], v[108:111]
    ds_read_b64_tr_b16 v[98:99], v6 offset:12768
    s_add_u32 m0, s3, 12544
    s_nop 0
    global_load_lds_dwordx4 v211, s[24:25] offset:768
    s_waitcnt lgkmcnt(9)
    v_mfma_f32_16x16x32_bf16 v[112:115], v[40:43], v[80:83], v[112:115]
    ds_read_b64_tr_b16 v[100:101], v7 offset:12544
    ds_read_b64_tr_b16 v[102:103], v7 offset:12768
    v_mfma_f32_16x16x32_bf16 v[116:119], v[40:43], v[84:87], v[116:119]
    s_add_u32 m0, s33, 24576
    s_add_u32 s32, s32, 2048
    buffer_load_dwordx4 v212, s[28:31], s32 offen lds
    s_lshl4_add_u32 s79, s35, 13018304
    s_waitcnt vmcnt(8)
    s_barrier
    s_waitcnt lgkmcnt(8)
    v_mfma_f32_16x16x32_bf16 v[124:127], v[44:47], v[44:47], v[124:127]
    ds_read_b128 v[48:51], v208 offset:8192
    ds_read_b64_tr_b16 v[136:137], v8 offset:14336
    v_mfma_f32_16x16x32_bf16 v[120:123], v[132:135], v[44:47], v[120:123]
    ds_read_b64_tr_b16 v[138:139], v8 offset:14560
    ds_read_b64_tr_b16 v[72:73], v4 offset:14336
    v_mfma_f32_16x16x32_bf16 v[128:131], v[140:143], v[132:135], v[128:131]
    ds_read_b64_tr_b16 v[74:75], v4 offset:14560
    ds_read_b64_tr_b16 v[76:77], v5 offset:14336
    s_waitcnt lgkmcnt(10)
    v_mfma_f32_16x16x32_bf16 v[104:107], v[88:91], v[44:47], v[104:107]
    ds_read_b64_tr_b16 v[78:79], v5 offset:14560
    ds_read_b64_tr_b16 v[80:81], v6 offset:14336
    v_mfma_f32_16x16x32_bf16 v[108:111], v[92:95], v[44:47], v[108:111]
    ds_read_b64_tr_b16 v[82:83], v6 offset:14560
    s_waitcnt lgkmcnt(9)
    v_mfma_f32_16x16x32_bf16 v[112:115], v[44:47], v[96:99], v[112:115]
    ds_read_b64_tr_b16 v[84:85], v7 offset:14336
    ds_read_b64_tr_b16 v[86:87], v7 offset:14560
    v_mfma_f32_16x16x32_bf16 v[116:119], v[44:47], v[100:103], v[116:119]
    s_waitcnt lgkmcnt(8)
    v_mfma_f32_16x16x32_bf16 v[124:127], v[48:51], v[48:51], v[124:127]
    ds_read_b128 v[52:55], v209 offset:8192
    ds_read_b64_tr_b16 v[140:141], v8 offset:16128
    v_mfma_f32_16x16x32_bf16 v[120:123], v[132:135], v[48:51], v[120:123]
    ds_read_b64_tr_b16 v[142:143], v8 offset:16352
    ds_read_b64_tr_b16 v[88:89], v4 offset:16128
    v_mfma_f32_16x16x32_bf16 v[128:131], v[136:139], v[132:135], v[128:131]
    ds_read_b64_tr_b16 v[90:91], v4 offset:16352
    ds_read_b64_tr_b16 v[92:93], v5 offset:16128
    s_waitcnt lgkmcnt(10)
    v_mfma_f32_16x16x32_bf16 v[104:107], v[72:75], v[48:51], v[104:107]
    ds_read_b64_tr_b16 v[94:95], v5 offset:16352
    ds_read_b64_tr_b16 v[96:97], v6 offset:16128
    v_mfma_f32_16x16x32_bf16 v[108:111], v[76:79], v[48:51], v[108:111]
    ds_read_b64_tr_b16 v[98:99], v6 offset:16352
    s_waitcnt lgkmcnt(9)
    v_mfma_f32_16x16x32_bf16 v[112:115], v[48:51], v[80:83], v[112:115]
    ds_read_b64_tr_b16 v[100:101], v7 offset:16128
    ds_read_b64_tr_b16 v[102:103], v7 offset:16352
    v_mfma_f32_16x16x32_bf16 v[116:119], v[48:51], v[84:87], v[116:119]
    s_waitcnt vmcnt(4)
    s_barrier
    s_waitcnt lgkmcnt(8)
    v_mfma_f32_16x16x32_bf16 v[124:127], v[52:55], v[52:55], v[124:127]
    ds_read_b128 v[56:59], v208 offset:10240
    ds_read_b64_tr_b16 v[136:137], v8 offset:17920
    v_mfma_f32_16x16x32_bf16 v[120:123], v[132:135], v[52:55], v[120:123]
    ds_read_b64_tr_b16 v[138:139], v8 offset:18144
    ds_read_b64_tr_b16 v[72:73], v4 offset:17920
    v_mfma_f32_16x16x32_bf16 v[128:131], v[140:143], v[132:135], v[128:131]
    ds_read_b64_tr_b16 v[74:75], v4 offset:18144
    ds_read_b64_tr_b16 v[76:77], v5 offset:17920
    s_waitcnt lgkmcnt(10)
    v_mfma_f32_16x16x32_bf16 v[104:107], v[88:91], v[52:55], v[104:107]
    ds_read_b64_tr_b16 v[78:79], v5 offset:18144
    ds_read_b64_tr_b16 v[80:81], v6 offset:17920
    v_mfma_f32_16x16x32_bf16 v[108:111], v[92:95], v[52:55], v[108:111]
    ds_read_b64_tr_b16 v[82:83], v6 offset:18144
    s_waitcnt lgkmcnt(9)
    v_mfma_f32_16x16x32_bf16 v[112:115], v[52:55], v[96:99], v[112:115]
    ds_read_b64_tr_b16 v[84:85], v7 offset:17920
    ds_read_b64_tr_b16 v[86:87], v7 offset:18144
    v_mfma_f32_16x16x32_bf16 v[116:119], v[52:55], v[100:103], v[116:119]
    s_waitcnt lgkmcnt(8)
    v_mfma_f32_16x16x32_bf16 v[124:127], v[56:59], v[56:59], v[124:127]
    ds_read_b128 v[60:63], v209 offset:10240
    ds_read_b64_tr_b16 v[140:141], v8 offset:19712
    v_mfma_f32_16x16x32_bf16 v[120:123], v[132:135], v[56:59], v[120:123]
    ds_read_b64_tr_b16 v[142:143], v8 offset:19936
    ds_read_b64_tr_b16 v[88:89], v4 offset:19712
    v_mfma_f32_16x16x32_bf16 v[128:131], v[136:139], v[132:135], v[128:131]
    ds_read_b64_tr_b16 v[90:91], v4 offset:19936
    ds_read_b64_tr_b16 v[92:93], v5 offset:19712
    s_waitcnt lgkmcnt(10)
    v_mfma_f32_16x16x32_bf16 v[104:107], v[72:75], v[56:59], v[104:107]
    ds_read_b64_tr_b16 v[94:95], v5 offset:19936
    ds_read_b64_tr_b16 v[96:97], v6 offset:19712
    v_mfma_f32_16x16x32_bf16 v[108:111], v[76:79], v[56:59], v[108:111]
    ds_read_b64_tr_b16 v[98:99], v6 offset:19936
    s_waitcnt lgkmcnt(9)
    v_mfma_f32_16x16x32_bf16 v[112:115], v[56:59], v[80:83], v[112:115]
    ds_read_b64_tr_b16 v[100:101], v7 offset:19712
    ds_read_b64_tr_b16 v[102:103], v7 offset:19936
    v_mfma_f32_16x16x32_bf16 v[116:119], v[56:59], v[84:87], v[116:119]
    s_waitcnt vmcnt(0)
    s_barrier
    s_waitcnt lgkmcnt(8)
    v_mfma_f32_16x16x32_bf16 v[124:127], v[60:63], v[60:63], v[124:127]
    ds_read_b128 v[64:67], v208 offset:12288
    ds_read_b64_tr_b16 v[136:137], v8 offset:21504
    v_mfma_f32_16x16x32_bf16 v[120:123], v[132:135], v[60:63], v[120:123]
    ds_read_b64_tr_b16 v[138:139], v8 offset:21728
    ds_read_b64_tr_b16 v[72:73], v4 offset:21504
    v_mfma_f32_16x16x32_bf16 v[128:131], v[140:143], v[132:135], v[128:131]
    ds_read_b64_tr_b16 v[74:75], v4 offset:21728
    ds_read_b64_tr_b16 v[76:77], v5 offset:21504
    s_waitcnt lgkmcnt(10)
    v_mfma_f32_16x16x32_bf16 v[104:107], v[88:91], v[60:63], v[104:107]
    ds_read_b64_tr_b16 v[78:79], v5 offset:21728
    ds_read_b64_tr_b16 v[80:81], v6 offset:21504
    v_mfma_f32_16x16x32_bf16 v[108:111], v[92:95], v[60:63], v[108:111]
    ds_read_b64_tr_b16 v[82:83], v6 offset:21728
    s_waitcnt lgkmcnt(9)
    v_mfma_f32_16x16x32_bf16 v[112:115], v[60:63], v[96:99], v[112:115]
    ds_read_b64_tr_b16 v[84:85], v7 offset:21504
    ds_read_b64_tr_b16 v[86:87], v7 offset:21728
    v_mfma_f32_16x16x32_bf16 v[116:119], v[60:63], v[100:103], v[116:119]
    s_waitcnt lgkmcnt(8)
    v_mfma_f32_16x16x32_bf16 v[124:127], v[64:67], v[64:67], v[124:127]
    ds_read_b128 v[68:71], v209 offset:12288
    ds_read_b64_tr_b16 v[140:141], v8 offset:23296
    v_mfma_f32_16x16x32_bf16 v[120:123], v[132:135], v[64:67], v[120:123]
    ds_read_b64_tr_b16 v[142:143], v8 offset:23520
    ds_read_b64_tr_b16 v[88:89], v4 offset:23296
    v_mfma_f32_16x16x32_bf16 v[128:131], v[136:139], v[132:135], v[128:131]
    ds_read_b64_tr_b16 v[90:91], v4 offset:23520
    ds_read_b64_tr_b16 v[92:93], v5 offset:23296
    s_waitcnt lgkmcnt(10)
    v_mfma_f32_16x16x32_bf16 v[104:107], v[72:75], v[64:67], v[104:107]
    ds_read_b64_tr_b16 v[94:95], v5 offset:23520
    ds_read_b64_tr_b16 v[96:97], v6 offset:23296
    v_mfma_f32_16x16x32_bf16 v[108:111], v[76:79], v[64:67], v[108:111]
    ds_read_b64_tr_b16 v[98:99], v6 offset:23520
    s_waitcnt lgkmcnt(9)
    v_mfma_f32_16x16x32_bf16 v[112:115], v[64:67], v[80:83], v[112:115]
    ds_read_b64_tr_b16 v[100:101], v7 offset:23296
    ds_read_b64_tr_b16 v[102:103], v7 offset:23520
    v_mfma_f32_16x16x32_bf16 v[116:119], v[64:67], v[84:87], v[116:119]
    s_waitcnt lgkmcnt(8)
    v_mfma_f32_16x16x32_bf16 v[124:127], v[68:71], v[68:71], v[124:127]
    v_mfma_f32_16x16x32_bf16 v[120:123], v[132:135], v[68:71], v[120:123]
    v_mfma_f32_16x16x32_bf16 v[128:131], v[140:143], v[132:135], v[128:131]
    s_waitcnt lgkmcnt(4)
    v_mfma_f32_16x16x32_bf16 v[104:107], v[88:91], v[68:71], v[104:107]
    v_mfma_f32_16x16x32_bf16 v[108:111], v[92:95], v[68:71], v[108:111]
    s_nop 4
    ds_write_b128 v12, v[128:131] offset:57344
    s_waitcnt lgkmcnt(1)
    v_mfma_f32_16x16x32_bf16 v[112:115], v[68:71], v[96:99], v[112:115]
    v_mfma_f32_16x16x32_bf16 v[116:119], v[68:71], v[100:103], v[116:119]
    v_cndmask_b32 v124, v124, v125, s[4:5]
    v_cndmask_b32 v126, v126, v127, s[12:13]
    v_mul_f32 v120, 0x3b124925, v120
    s_or_b64 s[6:7], s[6:7], s[12:13]
    v_cndmask_b32 v124, v124, v126, s[6:7]
    v_cndmask_b32 v124, 0, v124, s[20:21]
    v_cvt_pk_bf16_f32 v14, v120, v120
    s_waitcnt lgkmcnt(0)
    s_barrier
    v_lshlrev_b32 v6, 4, v3
    v_lshlrev_b32 v7, 2, v2
    v_add_u32 v7, 57344, v7
    ds_read_b128 v[72:75], v6 offset:57344
    ds_read_b128 v[76:79], v6 offset:57408
    ds_read2_b32 v[80:81], v7 offset0:32 offset1:48
    v_mov_b32 v15, v124
    s_nop 1
    v_permlane16_swap_b32 v124, v15
    v_add_f32 v124, v124, v15
    v_mul_f32 v120, v120, v120
    v_mov_b32 v15, v124
    s_nop 1
    v_permlane32_swap_b32 v124, v15
    v_add_f32 v124, v124, v15
    s_mov_b32 s26, 0x3b124925
    v_lshlrev_b32 v14, 16, v14
    v_fma_f32 v15, v124, s26, -v120
    v_max_f32 v15, 0, v15
    v_cvt_pk_bf16_f32 v15, v15, v15
    v_lshlrev_b32 v15, 16, v15
    v_add_f32 v15, 0x3727c5ac, v15
    v_cvt_pk_bf16_f32 v15, v15, v15
    v_lshlrev_b32 v15, 16, v15
    v_sqrt_f32 v15, v15
    s_nop 0
    v_cvt_pk_bf16_f32 v15, v15, v15
    v_lshlrev_b32 v15, 16, v15
    v_rcp_f32 v15, v15
    s_lshl_b32 s19, s18, 7
    v_add_u32 v7, s19, v7
    v_add_u32 v6, s19, v6
    v_mul_f32 v120, v14, v15
    ds_write2_b32 v7, v15, v120 offset0:64 offset1:80
    s_lshl_b32 s19, s16, 12
    s_add_u32 s19, s19, 12582912
    s_lshl_b32 s26, s34, 8
    s_add_u32 s26, s26, s19
    v_lshl_add_u32 v8, v2, 4, s26
    v_lshl_add_u32 v8, v3, 9, v8
    s_waitcnt lgkmcnt(0)
    ds_read_b128 v[84:87], v6 offset:57600
    ds_read_b128 v[88:91], v6 offset:57664
    v_fma_f32 v104, -v14, v72, v104
    v_fma_f32 v105, -v14, v73, v105
    v_fma_f32 v106, -v14, v74, v106
    v_fma_f32 v107, -v14, v75, v107
    v_fma_f32 v108, -v14, v76, v108
    v_fma_f32 v109, -v14, v77, v109
    v_fma_f32 v110, -v14, v78, v110
    v_fma_f32 v111, -v14, v79, v111
    s_mov_b32 s20, 0
    s_mov_b32 s21, 0xffff0000
    v_mul_f32 v104, v15, v104
    v_mul_f32 v105, v15, v105
    v_mul_f32 v106, v15, v106
    v_mul_f32 v107, v15, v107
    v_mul_f32 v108, v15, v108
    v_mul_f32 v109, v15, v109
    v_mul_f32 v110, v15, v110
    v_mul_f32 v111, v15, v111
    v_cndmask_b32 v108, v108, 0, s[20:21]
    v_cndmask_b32 v109, v109, 0, s[20:21]
    v_cndmask_b32 v110, v110, 0, s[20:21]
    v_cndmask_b32 v111, v111, 0, s[20:21]
    v_mul_f32 v9, v104, v104
    v_mul_f32 v10, v105, v105
    v_fmac_f32 v9, v106, v106
    v_fmac_f32 v10, v107, v107
    v_fmac_f32 v9, v108, v108
    v_fmac_f32 v10, v109, v109
    v_fmac_f32 v9, v110, v110
    v_fmac_f32 v10, v111, v111
    v_cvt_pk_bf16_f32 v16, v104, v105
    v_cvt_pk_bf16_f32 v17, v106, v107
    v_cvt_pk_bf16_f32 v18, v108, v109
    v_cvt_pk_bf16_f32 v19, v110, v111
    v_mov_b32 v11, 0x3f80
    v_add_f32 v9, v9, v10
    v_cndmask_b32 v18, v18, v132, s[20:21]
    v_cndmask_b32 v19, v19, v11, s[20:21]
    global_store_dwordx4 v8, v[16:19], s[14:15] sc1
    s_lshl_b32 s26, s34, 10
    s_add_u32 s26, s26, s19
    v_lshl_add_u32 v8, v2, 4, s26
    v_and_b32 v10, 1, v3
    v_lshl_add_u32 v8, v10, 9, v8
    v_lshrrev_b32 v10, 1, v3
    v_lshl_add_u32 v8, v10, 3, v8
    s_lshl_b32 s26, s16, 11
    s_sub_u32 s26, 262144, s26
    v_add_u32 v11, s26, v8
    s_mov_b32 s20, 0xf000f000
    s_mov_b32 s21, 0xf000f000
    s_mov_b32 s4, 0x10001000
    s_mov_b32 s5, 0x10001000
    s_lshl4_add_u32 s19, s35, 12976128
    v_lshl_add_u32 v7, v1, 12, s19
    v_mov_b32 v234, s96
    v_mov_b32 v235, s97
    s_waitcnt lgkmcnt(0)
    v_mul_f32 v112, v112, v84
    v_mul_f32 v113, v113, v85
    v_mul_f32 v114, v114, v86
    v_mul_f32 v115, v115, v87
    v_mul_f32 v116, v116, v84
    v_mul_f32 v117, v117, v85
    v_mul_f32 v118, v118, v86
    v_mul_f32 v119, v119, v87
    v_mov_b32 v10, v9
    s_nop 1
    v_permlane16_swap_b32 v9, v10
    v_add_f32 v9, v9, v10
    v_fma_f32 v112, -v88, v80, v112
    v_fma_f32 v113, -v89, v80, v113
    v_fma_f32 v114, -v90, v80, v114
    v_fma_f32 v115, -v91, v80, v115
    v_fma_f32 v116, -v88, v81, v116
    v_fma_f32 v117, -v89, v81, v117
    v_fma_f32 v118, -v90, v81, v118
    v_fma_f32 v119, -v91, v81, v119
    v_mov_b32 v10, v9
    s_nop 1
    v_permlane32_swap_b32 v9, v10
    v_add_f32 v9, v9, v10
    v_cndmask_b32 v116, v116, 0, s[20:21]
    v_cndmask_b32 v117, v117, 0, s[20:21]
    v_cndmask_b32 v118, v118, 0, s[20:21]
    v_cndmask_b32 v119, v119, 0, s[20:21]
    v_max3_f32 v10, |v112|, |v113|, |v114|
    v_max3_f32 v12, |v115|, |v116|, |v117|
    v_max3_f32 v10, v10, |v118|, |v119|
    v_max_f32 v10, v10, v12
    v_mul_f32 v10, v10, v10
    v_cndmask_b32 v116, v116, 1.0, s[4:5]
    v_cndmask_b32 v117, v117, 1.0, s[4:5]
    v_cndmask_b32 v118, v118, 1.0, s[4:5]
    v_cndmask_b32 v119, v119, 1.0, s[4:5]
    v_cvt_pk_f16_f32 v20, v112, v113
    v_cvt_pk_f16_f32 v21, v114, v115
    v_cvt_pk_f16_f32 v22, v116, v117
    v_cvt_pk_f16_f32 v23, v118, v119
    global_store_dwordx2 v8, v[20:21], s[14:15] offset:2048 sc1
    global_store_dwordx2 v8, v[22:23], s[14:15] offset:2304 sc1
    v_mov_b32 v12, v10
    s_nop 1
    v_permlane16_swap_b32 v10, v12
    v_max_f32 v10, v10, v12
    v_max_f32_dpp v9, v9, v9 row_ror:8 row_mask:0xf bank_mask:0xf
    s_nop 1
    v_max_f32_dpp v9, v9, v9 row_ror:4 row_mask:0xf bank_mask:0xf
    s_nop 1
    v_max_f32_dpp v9, v9, v9 row_ror:2 row_mask:0xf bank_mask:0xf
    s_nop 1
    v_max_f32_dpp v9, v9, v9 row_ror:1 row_mask:0xf bank_mask:0xf
    v_mov_b32 v12, v10
    s_nop 1
    v_permlane32_swap_b32 v10, v12
    v_max_f32 v10, v10, v12
    s_nop 1
    v_max_f32_dpp v10, v10, v10 row_ror:8 row_mask:0xf bank_mask:0xf
    s_nop 1
    v_max_f32_dpp v10, v10, v10 row_ror:4 row_mask:0xf bank_mask:0xf
    s_nop 1
    v_max_f32_dpp v10, v10, v10 row_ror:2 row_mask:0xf bank_mask:0xf
    s_nop 1
    v_max_f32_dpp v10, v10, v10 row_ror:1 row_mask:0xf bank_mask:0xf
    v_mov_b32 v232, v9
    v_mov_b32 v233, v10
    s_mov_b64 exec, 0xff
    global_store_dwordx4 v7, v[232:235], s[14:15] sc1
    s_mov_b64 exec, -1
    v_cvt_pk_bf16_f32 v24, v112, v113
    v_cvt_pk_bf16_f32 v25, v114, v115
    v_cvt_pk_bf16_f32 v26, v116, v117
    v_cvt_pk_bf16_f32 v27, v118, v119
    global_store_dwordx2 v11, v[24:25], s[14:15] offset:0 sc1
    global_store_dwordx2 v11, v[26:27], s[14:15] offset:256 sc1
    v_mov_b32 v255, 0
    s_mov_b64 s[66:67], 0
    s_mov_b64 s[68:69], 0
    s_mov_b64 s[70:71], 0
k2_start:
    s_mov_b64 s[16:17], s[40:41]
    s_mov_b64 s[18:19], s[52:53]
    s_mov_b64 s[20:21], s[60:61]
    s_mov_b32 s78, 3
    s_mov_b32 s64, -1
    s_mov_b32 s65, 0x3ffffff
    s_mov_b32 s4, s14
    s_mov_b32 s5, s15
    s_mov_b32 s6, 0x10000000
    s_mov_b32 s7, 0x00020000
    s_cmp_lg_u32 s77, 0
    s_cbranch_scc1 k2_solo1
k2_restart:
    v_and_b32 v3, 63, v0
    v_lshrrev_b32 v4, 6, v0
    s_nop 0
    v_readfirstlane_b32 s3, v4
    v_lshlrev_b32 v1, 4, v3
    s_and_b32 s9, s2, 7
    s_and_b32 s96, s2, 0xe0
    s_lshl2_add_u32 s28, s9, s96
    s_bfe_u32 s96, s2, 0x20003
    s_add_u32 s28, s28, s96
    s_mov_b32 s73, 0
    s_add_u32 s12, s80, 800
    s_addc_u32 s13, s81, 0
    s_mov_b32 s8, 0
    s_lshl_b32 s10, s3, 16
    s_add_u32 s10, s10, 12582912
    s_mul_i32 s96, s3, 100352
    v_add_u32 v2, s96, v1
    s_lshl_b32 s9, s9, 12
    s_lshr_b32 s11, s2, 3
    s_and_b32 s96, s11, 1
    s_lshl_b32 s96, s96, 15
    s_add_u32 s96, s96, s10
    s_add_u32 s32, s96, s9
    s_xor_b32 s33, s32, 0x8000
    s_mul_i32 s96, s11, 37
    s_lshr_b32 s96, s96, 8
    s_mul_i32 s30, s96, 7
    s_sub_u32 s30, s11, s30
    s_lshl_b32 s30, s30, 12
    s_and_b32 s96, s96, 1
    s_lshl_b32 s96, s96, 15
    s_add_u32 s96, s96, s10
    s_lshl2_add_u32 s11, s11, s3
    s_mul_i32 s11, s11, 3136
    s_add_u32 s11, s11, 13107200
    s_add_u32 s30, s30, 0x1000
    s_cmp_eq_u32 s30, 0x8000
    s_cselect_b32 s30, 0x1000, s30
    s_add_u32 s29, s30, s9
    s_and_b32 s29, s29, 0x7000
    s_add_u32 s34, s29, s96
    s_xor_b32 s35, s34, 0x8000
    s_add_u32 s30, s30, 0x1000
    s_cmp_eq_u32 s30, 0x8000
    s_cselect_b32 s30, 0x1000, s30
    s_add_u32 s29, s30, s9
    s_and_b32 s29, s29, 0x7000
    s_add_u32 s36, s29, s96
    s_xor_b32 s37, s36, 0x8000
    s_add_u32 s30, s30, 0x1000
    s_cmp_eq_u32 s30, 0x8000
    s_cselect_b32 s30, 0x1000, s30
    s_add_u32 s29, s30, s9
    s_and_b32 s29, s29, 0x7000
    s_add_u32 s38, s29, s96
    s_xor_b32 s39, s38, 0x8000
    s_add_u32 s30, s30, 0x1000
    s_cmp_eq_u32 s30, 0x8000
    s_cselect_b32 s30, 0x1000, s30
    s_add_u32 s29, s30, s9
    s_and_b32 s29, s29, 0x7000
    s_add_u32 s40, s29, s96
    s_xor_b32 s41, s40, 0x8000
    s_add_u32 s30, s30, 0x1000
    s_cmp_eq_u32 s30, 0x8000
    s_cselect_b32 s30, 0x1000, s30
    s_add_u32 s29, s30, s9
    s_and_b32 s29, s29, 0x7000
    s_add_u32 s42, s29, s96
    s_xor_b32 s43, s42, 0x8000
    s_add_u32 s30, s30, 0x1000
    s_cmp_eq_u32 s30, 0x8000
    s_cselect_b32 s30, 0x1000, s30
    s_add_u32 s29, s30, s9
    s_and_b32 s29, s29, 0x7000
    s_add_u32 s44, s29, s96
    s_xor_b32 s45, s44, 0x8000
    s_add_u32 s30, s30, 0x1000
    s_cmp_eq_u32 s30, 0x8000
    s_cselect_b32 s30, 0x1000, s30
    s_add_u32 s29, s30, s9
    s_and_b32 s29, s29, 0x7000
    s_add_u32 s46, s29, s96
    s_xor_b32 s47, s46, 0x8000
    s_mov_b32 s26, 0x02000200
    s_mov_b32 s27, 0x3da83da8
    s_mov_b32 s23, 0xffff0000
    s_mov_b32 s24, 0x00ff00ff
    s_mov_b32 s25, 0x00ff00ff
    s_mov_b32 s48, 0xc80000
    s_mov_b32 s49, 0xc81000
    s_mov_b32 s50, 0xc82000
    s_mov_b32 s51, 0xc83000
    s_mov_b32 s52, 0xc84000
    s_mov_b32 s53, 0xc85000
    s_mov_b32 s54, 0xc86000
    s_mov_b32 s55, 0xc87000
    s_mov_b32 s56, 0xc88000
    s_mov_b32 s57, 0xc89000
    s_mov_b32 s58, 0xc8a000
    s_mov_b32 s59, 0xc8b000
    s_mov_b32 s60, 0xc8c000
    s_mov_b32 s61, 0xc8d000
    s_mov_b32 s62, 0xc8e000
    s_mov_b32 s63, 0xc8f000
    s_add_u32 s96, s3, 1
    s_and_b32 s96, s96, 3
    v_lshl_add_u32 v65, s96, 11, v1
    s_mul_i32 s96, s96, 3
    s_add_u32 s96, s96, 0
    s_lshl_b32 s96, s96, 12
    v_add_u32 v8, s96, v1
    s_add_u32 s96, s3, 2
    s_and_b32 s96, s96, 3
    v_lshl_add_u32 v66, s96, 11, v1
    s_mul_i32 s96, s96, 3
    s_add_u32 s96, s96, 1
    s_lshl_b32 s96, s96, 12
    v_add_u32 v9, s96, v1
    s_add_u32 s96, s3, 3
    s_and_b32 s96, s96, 3
    v_lshl_add_u32 v67, s96, 11, v1
    s_mul_i32 s96, s96, 3
    s_add_u32 s96, s96, 2
    s_lshl_b32 s96, s96, 12
    v_add_u32 v10, s96, v1
    v_lshl_add_u32 v64, s3, 11, v1
    s_mul_i32 s96, s3, 12288
    v_add_u32 v11, s96, v1
    v_and_b32 v12, 7, v0
    v_mul_u32_u24 v4, 912, v12
    v_bfe_u32 v5, v0, 3, 2
    v_mul_u32_u24 v5, 56, v5
    v_bfe_u32 v6, v0, 5, 1
    v_lshl_add_u32 v6, v6, 3, v5
    s_mul_i32 s96, s3, 224
    v_bfe_u32 v7, v0, 4, 2
    v_lshl_add_u32 v5, v7, 4, v4
    v_add3_u32 v4, v4, v6, s96
    v_bfe_u32 v6, v0, 3, 1
    v_lshl_add_u32 v7, v6, 2, v7
    v_mad_u32_u24 v13, v7, 28, s96
    s_lshl_b32 s22, s28, 3
    v_add_u32 v12, s22, v12
    v_mul_u32_u24 v7, 0x380, v12
    v_add_u32 v7, v7, v13
    v_or_b32 v12, 0x1000, v12
    s_memrealtime s[82:83]
    s_and_b32 s101, s2, 7
    s_mul_i32 s101, s101, 28
    s_lshr_b32 s96, s2, 3
    s_add_u32 s101, s101, s96
    s_mul_i32 s74, s101, 14336
    s_lshl_b32 s96, s3, 11
    s_add_u32 s74, s74, s96
    s_add_u32 s74, s74, 0x500000
    s_add_u32 s75, s74, 7168
    s_and_b32 s76, s2, 7
    s_bfe_u32 s96, s2, 0x20003
    s_lshl2_add_u32 s76, s76, s96
    s_min_u32 s96, s76, 27
    s_lshl3_add_u32 s96, s96, s3
    s_mul_i32 s96, s96, 7168
    s_add_u32 s96, s96, 0x810000
    s_cmp_ge_u32 s2, 224
    s_cselect_b32 s74, s96, s74
    s_add_u32 s96, s96, 28672
    s_cmp_ge_u32 s2, 224
    s_cselect_b32 s75, s96, s75
    s_lshr_b32 s96, s101, 3
    s_mul_i32 s9, s3, 56
    s_add_u32 s9, s9, s96
    s_min_u32 s96, s76, 27
    s_lshr_b32 s96, s96, 2
    s_mul_i32 s29, s3, 49
    s_add_u32 s96, s96, s29
    s_add_u32 s96, s96, 392
    s_cmp_eq_u32 s3, 3
    s_cselect_b32 s29, 1, 3
    s_movk_i32 s30, 3136
    s_movk_i32 s31, 448
    s_cmp_ge_u32 s2, 224
    s_cselect_b32 s9, s96, s9
    s_cselect_b32 s29, 6, s29
    s_cselect_b32 s30, 112, s30
    s_cselect_b32 s31, 224, s31
    s_lshl4_add_u32 s9, s9, 13008896
    v_and_b32 v14, 63, v0
    v_min_u32 v14, s29, v14
    v_and_b32 v15, 1, v14
    v_lshrrev_b32 v14, 1, v14
    v_mul_u32_u24 v15, s30, v15
    v_mul_u32_u24 v14, s31, v14
    v_add3_u32 v6, v14, v15, s9
    s_movk_i32 s9, 300
    s_waitcnt lgkmcnt(0)
    s_cmp_lg_u32 s77, 0
    s_cselect_b64 s[82:83], -1, s[82:83]
    global_load_dwordx4 v[128:131], v253, s[14:15] offset:0 sc1
    global_load_dwordx4 v[132:135], v253, s[14:15] offset:1024 sc1
    global_load_dwordx4 v[136:139], v253, s[14:15] offset:2048 sc1
    global_load_dwordx4 v[140:143], v253, s[14:15] offset:3072 sc1
    global_load_dwordx4 v[156:159], v254, s[14:15] offset:0 sc1
    global_load_dwordx4 v[160:163], v254, s[14:15] offset:1024 sc1
    global_load_dwordx4 v[180:183], v254, s[14:15] offset:2048 sc1
    global_load_dwordx4 v[184:187], v254, s[14:15] offset:3072 sc1
    global_load_dwordx2 v[144:145], v252, s[14:15] offset:2048 sc1
    global_load_dwordx4 v[148:151], v252, s[14:15] offset:0 sc1
    global_load_dwordx4 v[152:155], v252, s[14:15] offset:1024 sc1
    s_mul_i32 s30, s28, 3584
    s_add_u32 s30, s30, 0x400000
    s_mov_b32 s29, 0x3b124925
    v_mov_b32 v14, 0
    v_mov_b32 v15, 0
    s_waitcnt vmcnt(7)
k2_chkq:
    v_cmpx_le_u64 vcc, s[80:81], v[142:143]
    v_cmpx_ge_u64 vcc, s[82:83], v[142:143]
    s_nop 0
    s_mov_b32 exec_hi, -1
    v_cmpx_le_u64 vcc, s[80:81], v[130:131]
    v_cmpx_ge_u64 vcc, s[82:83], v[130:131]
    v_cmpx_le_u64 vcc, s[80:81], v[134:135]
    v_cmpx_ge_u64 vcc, s[82:83], v[134:135]
    v_cmpx_le_u64 vcc, s[80:81], v[138:139]
    v_cmpx_ge_u64 vcc, s[82:83], v[138:139]
    s_nop 0
    s_not_b64 exec, exec
    s_cbranch_scc1 k2_req
k2_goq:
    s_mov_b64 exec, -1
    v_pk_mov_b32 v[80:81], v[128:129], v[128:129] op_sel:[0,1]
    v_pk_mov_b32 v[82:83], v[136:137], v[136:137] op_sel:[0,1]
    v_pk_mov_b32 v[84:85], v[132:133], v[132:133] op_sel:[0,1]
    v_pk_mov_b32 v[86:87], v[140:141], v[140:141] op_sel:[0,1]
    s_mov_b32 exec_lo, 0
    v_mov_b32 v86, 0
    v_mov_b32 v87, 0
    s_mov_b64 exec, -1
    ds_write_b128 v64, v[80:83]
    v_dot2c_f32_bf16 v14, v80, v80
    v_dot2c_f32_bf16 v15, v81, v81
    v_dot2c_f32_bf16 v14, v82, v82
    v_dot2c_f32_bf16 v15, v83, v83
    v_dot2c_f32_bf16 v14, v84, v84
    v_dot2c_f32_bf16 v15, v85, v85
    v_dot2c_f32_bf16 v14, v86, v86
    v_dot2c_f32_bf16 v15, v87, v87
    s_nop 2
    v_add_f32 v14, v14, v15
    v_mov_b32 v15, v14
    s_nop 1
    v_permlane32_swap_b32 v14, v15
    v_add_f32 v14, v14, v15
    v_mul_f32 v176, 0x3f8292a3, v14
k2_chk:
    s_waitcnt vmcnt(2)
    v_mfma_f32_32x32x16_bf16 v[112:127], v[156:159], v[80:83], 0
    v_max3_u32 v3, v156, v160, v180
    v_cmp_le_u64 vcc, s[80:81], v[144:145]
    v_max3_u32 v3, v3, v182, v184
    v_cmp_ge_u64 s[96:97], s[82:83], v[144:145]
    v_max_u32 v3, v3, v186
    s_and_b64 s[98:99], vcc, s[96:97]
    v_cmp_ne_u32 vcc, -1, v3
    s_or_b32 s99, s99, 0xff000000
    s_waitcnt vmcnt(0)
    v_max_f32 v14, v148, v152
    v_max_f32 v15, v149, v153
    s_and_b64 s[98:99], s[98:99], vcc
    v_cmp_le_u64 vcc, s[80:81], v[150:151]
    v_permlane32_swap_b32 v14, v15
    v_max_f32 v14, v14, v15
    s_and_b64 s[98:99], s[98:99], vcc
    v_cmp_ge_u64 vcc, s[82:83], v[150:151]
    v_max_f32_dpp v14, v14, v14 row_ror:8 row_mask:0xf bank_mask:0xf
    s_and_b64 s[98:99], s[98:99], vcc
    v_cmp_le_u64 vcc, s[80:81], v[154:155]
    v_max_f32_dpp v14, v14, v14 row_ror:4 row_mask:0xf bank_mask:0xf
    s_and_b64 s[98:99], s[98:99], vcc
    v_cmp_ge_u64 vcc, s[82:83], v[154:155]
    v_max_f32_dpp v14, v14, v14 row_ror:2 row_mask:0xf bank_mask:0xf
    s_and_b64 s[98:99], s[98:99], vcc
    s_cmp_eq_u64 s[98:99], -1
    v_max_f32_dpp v14, v14, v14 row_ror:1 row_mask:0xf bank_mask:0xf
    v_mov_b32 v15, v14
    s_cbranch_scc0 k2_repoll
k2_go:
    s_nop 0
    v_permlane16_swap_b32 v14, v15
    v_max_f32 v14, v14, v15
    s_nop 0
    v_readlane_b32 s96, v14, 0
    v_readlane_b32 s97, v14, 32
    buffer_load_dwordx4 v[164:167], v1, s[4:7], s33 offen offset:0 sc1
    v_mul_f32 v14, s96, v176
    v_sqrt_f32 v14, v14
    s_mov_b32 exec_lo, 0
    v_sub_f32 v14, 0x3ee400e4, v14
    v_cvt_pk_bf16_f32 v86, v14, 0
    s_mov_b64 exec, -1
    ds_write_b128 v64, v[84:87] offset:1024
    v_mfma_f32_32x32x16_bf16 v[112:127], v[160:163], v[84:87], v[112:127]
    s_cmp_lt_u32 s97, 0x34800000
    s_cselect_b32 s31, 1, 0
    s_cmp_gt_u32 s97, 0x4d800000
    s_cselect_b32 s31, 1, s31
    buffer_load_dwordx4 v[168:171], v1, s[4:7], s33 offen offset:1024 sc1
    buffer_load_dwordx4 v[188:191], v1, s[4:7], s33 offen offset:2048 sc1
    buffer_load_dwordx4 v[192:195], v1, s[4:7], s33 offen offset:3072 sc1
    buffer_load_dwordx4 a[240:243], v1, s[4:7], s11 offen offset:0 sc1
    buffer_load_dwordx4 a[244:247], v1, s[4:7], s11 offen offset:1024 sc1
    buffer_load_dwordx4 a[248:251], v1, s[4:7], s11 offen offset:2048 sc1
    buffer_load_dwordx4 a[252:255], v1, s[4:7], s11 offen offset:3072 sc1
    s_waitcnt lgkmcnt(0)
    s_barrier
    ds_read_b128 v[88:91], v65 offset:0
    ds_read_b128 v[92:95], v65 offset:1024
    ds_read_b128 v[96:99], v66 offset:0
    ds_read_b128 v[100:103], v66 offset:1024
    ds_read_b128 v[104:107], v67 offset:0
    ds_read_b128 v[108:111], v67 offset:1024
    buffer_load_dwordx4 v[172:175], v1, s[4:7], s34 offen offset:0 sc1
    v_cvt_pknorm_u16_f32 v152, v112, v113
    v_cvt_pknorm_u16_f32 v153, v114, v115
    v_add_u32 v144, s26, v152
    v_add_u32 v145, s26, v153
    v_pk_fmac_f16 v144, s27, v152
    v_pk_fmac_f16 v145, s27, v153
    v_cvt_pknorm_u16_f32 v152, v116, v117
    v_cvt_pknorm_u16_f32 v153, v118, v119
    v_add_u32 v146, s26, v152
    v_add_u32 v147, s26, v153
    v_pk_fmac_f16 v146, s27, v152
    v_pk_fmac_f16 v147, s27, v153
    s_nop 1
    v_mfma_f32_32x32x16_f16 v[16:31], v[180:183], v[144:147], 0
    s_waitcnt lgkmcnt(4)
    v_mfma_f32_32x32x16_bf16 v[128:143], v[156:159], v[88:91], 0
    buffer_load_dwordx4 v[176:179], v1, s[4:7], s34 offen offset:1024 sc1
    v_cvt_pknorm_u16_f32 v152, v120, v121
    v_cvt_pknorm_u16_f32 v153, v122, v123
    v_add_u32 v148, s26, v152
    v_add_u32 v149, s26, v153
    v_pk_fmac_f16 v148, s27, v152
    v_pk_fmac_f16 v149, s27, v153
    v_mfma_f32_32x32x16_bf16 v[128:143], v[160:163], v[92:95], v[128:143]
    v_cvt_pknorm_u16_f32 v152, v124, v125
    v_cvt_pknorm_u16_f32 v153, v126, v127
    v_add_u32 v150, s26, v152
    v_add_u32 v151, s26, v153
    v_pk_fmac_f16 v150, s27, v152
    v_pk_fmac_f16 v151, s27, v153
    s_waitcnt lgkmcnt(0)
    v_mfma_f32_32x32x16_bf16 v[112:127], v[156:159], v[96:99], 0
    buffer_load_dwordx4 v[196:199], v1, s[4:7], s34 offen offset:2048 sc1
    s_nop 2
    v_cvt_pknorm_u16_f32 v152, v128, v129
    v_cvt_pknorm_u16_f32 v153, v130, v131
    v_add_u32 v144, s26, v152
    v_add_u32 v145, s26, v153
    v_pk_fmac_f16 v144, s27, v152
    v_pk_fmac_f16 v145, s27, v153
    v_mfma_f32_32x32x16_f16 v[16:31], v[184:187], v[148:151], v[16:31]
    v_cvt_pknorm_u16_f32 v152, v132, v133
    v_cvt_pknorm_u16_f32 v153, v134, v135
    v_add_u32 v146, s26, v152
    v_add_u32 v147, s26, v153
    v_pk_fmac_f16 v146, s27, v152
    v_pk_fmac_f16 v147, s27, v153
    v_mfma_f32_32x32x16_bf16 v[112:127], v[160:163], v[100:103], v[112:127]
    buffer_load_dwordx4 v[200:203], v1, s[4:7], s34 offen offset:3072 sc1
    v_cvt_pknorm_u16_f32 v152, v136, v137
    v_cvt_pknorm_u16_f32 v153, v138, v139
    v_add_u32 v148, s26, v152
    v_add_u32 v149, s26, v153
    v_pk_fmac_f16 v148, s27, v152
    v_pk_fmac_f16 v149, s27, v153
    v_mfma_f32_32x32x16_f16 v[32:47], v[180:183], v[144:147], 0
    v_cvt_pknorm_u16_f32 v152, v140, v141
    v_cvt_pknorm_u16_f32 v153, v142, v143
    v_add_u32 v150, s26, v152
    v_add_u32 v151, s26, v153
    v_pk_fmac_f16 v150, s27, v152
    v_pk_fmac_f16 v151, s27, v153
    v_mfma_f32_32x32x16_bf16 v[128:143], v[156:159], v[104:107], 0
    buffer_load_dwordx4 v[204:207], v2, s[4:7], s48 offen offset:0 sc1
    v_cvt_pknorm_u16_f32 v152, v112, v113
    v_cvt_pknorm_u16_f32 v153, v114, v115
    v_add_u32 v144, s26, v152
    v_add_u32 v145, s26, v153
    v_pk_fmac_f16 v144, s27, v152
    v_pk_fmac_f16 v145, s27, v153
    v_mfma_f32_32x32x16_f16 v[32:47], v[184:187], v[148:151], v[32:47]
    v_cvt_pknorm_u16_f32 v152, v116, v117
    v_cvt_pknorm_u16_f32 v153, v118, v119
    v_add_u32 v146, s26, v152
    v_add_u32 v147, s26, v153
    v_pk_fmac_f16 v146, s27, v152
    v_pk_fmac_f16 v147, s27, v153
    v_mfma_f32_32x32x16_bf16 v[128:143], v[160:163], v[108:111], v[128:143]
    buffer_load_dwordx4 v[156:159], v1, s[4:7], s35 offen offset:0 sc1
    v_cvt_pknorm_u16_f32 v152, v120, v121
    v_cvt_pknorm_u16_f32 v153, v122, v123
    v_add_u32 v148, s26, v152
    v_add_u32 v149, s26, v153
    v_pk_fmac_f16 v148, s27, v152
    v_pk_fmac_f16 v149, s27, v153
    v_mfma_f32_32x32x16_f16 v[48:63], v[180:183], v[144:147], 0
    v_cvt_pknorm_u16_f32 v152, v124, v125
    v_cvt_pknorm_u16_f32 v153, v126, v127
    v_add_u32 v150, s26, v152
    v_add_u32 v151, s26, v153
    v_pk_fmac_f16 v150, s27, v152
    v_pk_fmac_f16 v151, s27, v153
    s_waitcnt vmcnt(12)
    v_mfma_f32_32x32x16_bf16 v[112:127], v[164:167], v[88:91], 0
    buffer_load_dwordx4 v[208:211], v2, s[4:7], s48 offen offset:1024 sc1
    v_cvt_pknorm_u16_f32 v152, v128, v129
    v_cvt_pknorm_u16_f32 v153, v130, v131
    v_add_u32 v144, s26, v152
    v_add_u32 v145, s26, v153
    v_pk_fmac_f16 v144, s27, v152
    v_pk_fmac_f16 v145, s27, v153
    v_mfma_f32_32x32x16_f16 v[48:63], v[184:187], v[148:151], v[48:63]
    v_cvt_pknorm_u16_f32 v152, v132, v133
    v_cvt_pknorm_u16_f32 v153, v134, v135
    v_add_u32 v146, s26, v152
    v_add_u32 v147, s26, v153
    v_pk_fmac_f16 v146, s27, v152
    v_pk_fmac_f16 v147, s27, v153
    v_mfma_f32_32x32x16_bf16 v[112:127], v[168:171], v[92:95], v[112:127]
    buffer_load_dwordx4 v[160:163], v1, s[4:7], s35 offen offset:1024 sc1
    v_cvt_pknorm_u16_f32 v152, v136, v137
    v_cvt_pknorm_u16_f32 v153, v138, v139
    v_add_u32 v148, s26, v152
    v_add_u32 v149, s26, v153
    v_pk_fmac_f16 v148, s27, v152
    v_pk_fmac_f16 v149, s27, v153
    v_mfma_f32_32x32x16_f16 v[64:79], v[180:183], v[144:147], 0
    v_cvt_pknorm_u16_f32 v152, v140, v141
    v_cvt_pknorm_u16_f32 v153, v142, v143
    v_add_u32 v150, s26, v152
    v_add_u32 v151, s26, v153
    v_pk_fmac_f16 v150, s27, v152
    v_pk_fmac_f16 v151, s27, v153
    v_mfma_f32_32x32x16_bf16 v[128:143], v[164:167], v[96:99], 0
    v_max3_u32 v3, v3, v164, v168
    buffer_load_dwordx4 v[212:215], v2, s[4:7], s48 offen offset:2048 sc1
    v_cvt_pknorm_u16_f32 v152, v112, v113
    v_cvt_pknorm_u16_f32 v153, v114, v115
    v_add_u32 v144, s26, v152
    v_add_u32 v145, s26, v153
    v_pk_fmac_f16 v144, s27, v152
    v_pk_fmac_f16 v145, s27, v153
    v_mfma_f32_32x32x16_f16 v[64:79], v[184:187], v[148:151], v[64:79]
    s_mov_b64 exec, s[66:67]
    buffer_store_dwordx4 a[208:211], v255, s[4:7], s68 offen offset:0 sc1
    s_mov_b64 exec, -1
    v_cvt_pknorm_u16_f32 v152, v116, v117
    v_cvt_pknorm_u16_f32 v153, v118, v119
    v_add_u32 v146, s26, v152
    v_add_u32 v147, s26, v153
    v_pk_fmac_f16 v146, s27, v152
    v_pk_fmac_f16 v147, s27, v153
    v_mfma_f32_32x32x16_bf16 v[128:143], v[168:171], v[100:103], v[128:143]
    buffer_load_dwordx4 v[180:183], v1, s[4:7], s35 offen offset:2048 sc1
    v_cvt_pknorm_u16_f32 v152, v120, v121
    v_cvt_pknorm_u16_f32 v153, v122, v123
    v_add_u32 v148, s26, v152
    v_add_u32 v149, s26, v153
    v_pk_fmac_f16 v148, s27, v152
    v_pk_fmac_f16 v149, s27, v153
    s_waitcnt vmcnt(15)
    v_mfma_f32_32x32x16_f16 v[32:47], v[188:191], v[144:147], v[32:47]
    v_cvt_pknorm_u16_f32 v152, v124, v125
    v_cvt_pknorm_u16_f32 v153, v126, v127
    v_add_u32 v150, s26, v152
    v_add_u32 v151, s26, v153
    v_pk_fmac_f16 v150, s27, v152
    v_pk_fmac_f16 v151, s27, v153
    v_mfma_f32_32x32x16_bf16 v[112:127], v[164:167], v[104:107], 0
    buffer_load_dwordx4 v[216:219], v2, s[4:7], s48 offen offset:3072 sc1
    v_cvt_pknorm_u16_f32 v152, v128, v129
    v_cvt_pknorm_u16_f32 v153, v130, v131
    v_add_u32 v144, s26, v152
    v_add_u32 v145, s26, v153
    v_pk_fmac_f16 v144, s27, v152
    v_pk_fmac_f16 v145, s27, v153
    v_mfma_f32_32x32x16_f16 v[32:47], v[192:195], v[148:151], v[32:47]
    v_cvt_pknorm_u16_f32 v152, v132, v133
    v_cvt_pknorm_u16_f32 v153, v134, v135
    v_add_u32 v146, s26, v152
    v_add_u32 v147, s26, v153
    v_pk_fmac_f16 v146, s27, v152
    v_pk_fmac_f16 v147, s27, v153
    v_mfma_f32_32x32x16_bf16 v[112:127], v[168:171], v[108:111], v[112:127]
    buffer_load_dwordx4 v[184:187], v1, s[4:7], s35 offen offset:3072 sc1
    v_cvt_pknorm_u16_f32 v152, v136, v137
    v_cvt_pknorm_u16_f32 v153, v138, v139
    v_add_u32 v148, s26, v152
    v_add_u32 v149, s26, v153
    v_pk_fmac_f16 v148, s27, v152
    v_pk_fmac_f16 v149, s27, v153
    v_mfma_f32_32x32x16_f16 v[48:63], v[188:191], v[144:147], v[48:63]
    v_cvt_pknorm_u16_f32 v152, v140, v141
    v_cvt_pknorm_u16_f32 v153, v142, v143
    v_add_u32 v150, s26, v152
    v_add_u32 v151, s26, v153
    v_pk_fmac_f16 v150, s27, v152
    v_pk_fmac_f16 v151, s27, v153
    v_mfma_f32_32x32x16_bf16 v[128:143], v[164:167], v[80:83], 0
    buffer_load_dwordx4 v[220:223], v2, s[4:7], s49 offen offset:0 sc1
    v_cvt_pknorm_u16_f32 v152, v112, v113
    v_cvt_pknorm_u16_f32 v153, v114, v115
    v_add_u32 v144, s26, v152
    v_add_u32 v145, s26, v153
    v_pk_fmac_f16 v144, s27, v152
    v_pk_fmac_f16 v145, s27, v153
    v_mfma_f32_32x32x16_f16 v[48:63], v[192:195], v[148:151], v[48:63]
    s_mov_b64 exec, s[66:67]
    buffer_store_dwordx4 a[212:215], v255, s[4:7], s68 offen offset:512 sc1
    s_mov_b64 exec, -1
    v_cvt_pknorm_u16_f32 v152, v116, v117
    v_cvt_pknorm_u16_f32 v153, v118, v119
    v_add_u32 v146, s26, v152
    v_add_u32 v147, s26, v153
    v_pk_fmac_f16 v146, s27, v152
    v_pk_fmac_f16 v147, s27, v153
    v_mfma_f32_32x32x16_bf16 v[128:143], v[168:171], v[84:87], v[128:143]
    buffer_load_dwordx4 v[164:167], v1, s[4:7], s36 offen offset:0 sc1
    v_cvt_pknorm_u16_f32 v152, v120, v121
    v_cvt_pknorm_u16_f32 v153, v122, v123
    v_add_u32 v148, s26, v152
    v_add_u32 v149, s26, v153
    v_pk_fmac_f16 v148, s27, v152
    v_pk_fmac_f16 v149, s27, v153
    v_mfma_f32_32x32x16_f16 v[64:79], v[188:191], v[144:147], v[64:79]
    v_cvt_pknorm_u16_f32 v152, v124, v125
    v_cvt_pknorm_u16_f32 v153, v126, v127
    v_add_u32 v150, s26, v152
    v_add_u32 v151, s26, v153
    v_pk_fmac_f16 v150, s27, v152
    v_pk_fmac_f16 v151, s27, v153
    s_waitcnt vmcnt(14)
    v_mfma_f32_32x32x16_bf16 v[112:127], v[172:175], v[88:91], 0
    buffer_load_dwordx4 v[224:227], v2, s[4:7], s49 offen offset:1024 sc1
    v_cvt_pknorm_u16_f32 v152, v128, v129
    v_cvt_pknorm_u16_f32 v153, v130, v131
    v_add_u32 v144, s26, v152
    v_add_u32 v145, s26, v153
    v_pk_fmac_f16 v144, s27, v152
    v_pk_fmac_f16 v145, s27, v153
    v_mfma_f32_32x32x16_f16 v[64:79], v[192:195], v[148:151], v[64:79]
    v_cvt_pknorm_u16_f32 v152, v132, v133
    v_cvt_pknorm_u16_f32 v153, v134, v135
    v_add_u32 v146, s26, v152
    v_add_u32 v147, s26, v153
    v_pk_fmac_f16 v146, s27, v152
    v_pk_fmac_f16 v147, s27, v153
    v_mfma_f32_32x32x16_bf16 v[112:127], v[176:179], v[92:95], v[112:127]
    buffer_load_dwordx4 v[168:171], v1, s[4:7], s36 offen offset:1024 sc1
    v_cvt_pknorm_u16_f32 v152, v136, v137
    v_cvt_pknorm_u16_f32 v153, v138, v139
    v_add_u32 v148, s26, v152
    v_add_u32 v149, s26, v153
    v_pk_fmac_f16 v148, s27, v152
    v_pk_fmac_f16 v149, s27, v153
    v_mfma_f32_32x32x16_f16 v[16:31], v[188:191], v[144:147], v[16:31]
    v_cvt_pknorm_u16_f32 v152, v140, v141
    v_cvt_pknorm_u16_f32 v153, v142, v143
    v_add_u32 v150, s26, v152
    v_add_u32 v151, s26, v153
    v_pk_fmac_f16 v150, s27, v152
    v_pk_fmac_f16 v151, s27, v153
    v_mfma_f32_32x32x16_bf16 v[128:143], v[172:175], v[96:99], 0
    v_max3_u32 v3, v3, v172, v176
    buffer_load_dwordx4 v[228:231], v2, s[4:7], s49 offen offset:2048 sc1
    v_cvt_pknorm_u16_f32 v152, v112, v113
    v_cvt_pknorm_u16_f32 v153, v114, v115
    v_add_u32 v144, s26, v152
    v_add_u32 v145, s26, v153
    v_pk_fmac_f16 v144, s27, v152
    v_pk_fmac_f16 v145, s27, v153
    v_mfma_f32_32x32x16_f16 v[16:31], v[192:195], v[148:151], v[16:31]
    s_mov_b64 exec, s[66:67]
    buffer_store_dwordx4 a[216:219], v255, s[4:7], s69 offen offset:0 sc1
    s_mov_b64 exec, -1
    v_cvt_pknorm_u16_f32 v152, v116, v117
    v_cvt_pknorm_u16_f32 v153, v118, v119
    v_add_u32 v146, s26, v152
    v_add_u32 v147, s26, v153
    v_pk_fmac_f16 v146, s27, v152
    v_pk_fmac_f16 v147, s27, v153
    v_mfma_f32_32x32x16_bf16 v[128:143], v[176:179], v[100:103], v[128:143]
    buffer_load_dwordx4 v[188:191], v1, s[4:7], s36 offen offset:2048 sc1
    v_cvt_pknorm_u16_f32 v152, v120, v121
    v_cvt_pknorm_u16_f32 v153, v122, v123
    v_add_u32 v148, s26, v152
    v_add_u32 v149, s26, v153
    v_pk_fmac_f16 v148, s27, v152
    v_pk_fmac_f16 v149, s27, v153
    s_waitcnt vmcnt(17)
    v_mfma_f32_32x32x16_f16 v[32:47], v[196:199], v[144:147], v[32:47]
    v_cvt_pknorm_u16_f32 v152, v124, v125
    v_cvt_pknorm_u16_f32 v153, v126, v127
    v_add_u32 v150, s26, v152
    v_add_u32 v151, s26, v153
    v_pk_fmac_f16 v150, s27, v152
    v_pk_fmac_f16 v151, s27, v153
    v_mfma_f32_32x32x16_bf16 v[112:127], v[172:175], v[104:107], 0
    buffer_load_dwordx4 v[232:235], v2, s[4:7], s49 offen offset:3072 sc1
    v_cvt_pknorm_u16_f32 v152, v128, v129
    v_cvt_pknorm_u16_f32 v153, v130, v131
    v_add_u32 v144, s26, v152
    v_add_u32 v145, s26, v153
    v_pk_fmac_f16 v144, s27, v152
    v_pk_fmac_f16 v145, s27, v153
    v_mfma_f32_32x32x16_f16 v[32:47], v[200:203], v[148:151], v[32:47]
    v_cvt_pknorm_u16_f32 v152, v132, v133
    v_cvt_pknorm_u16_f32 v153, v134, v135
    v_add_u32 v146, s26, v152
    v_add_u32 v147, s26, v153
    v_pk_fmac_f16 v146, s27, v152
    v_pk_fmac_f16 v147, s27, v153
    v_mfma_f32_32x32x16_bf16 v[112:127], v[176:179], v[108:111], v[112:127]
    buffer_load_dwordx4 v[192:195], v1, s[4:7], s36 offen offset:3072 sc1
    v_cvt_pknorm_u16_f32 v152, v136, v137
    v_cvt_pknorm_u16_f32 v153, v138, v139
    v_add_u32 v148, s26, v152
    v_add_u32 v149, s26, v153
    v_pk_fmac_f16 v148, s27, v152
    v_pk_fmac_f16 v149, s27, v153
    v_mfma_f32_32x32x16_f16 v[48:63], v[196:199], v[144:147], v[48:63]
    v_cvt_pknorm_u16_f32 v152, v140, v141
    v_cvt_pknorm_u16_f32 v153, v142, v143
    v_add_u32 v150, s26, v152
    v_add_u32 v151, s26, v153
    v_pk_fmac_f16 v150, s27, v152
    v_pk_fmac_f16 v151, s27, v153
    v_mfma_f32_32x32x16_bf16 v[128:143], v[172:175], v[80:83], 0
    buffer_load_dwordx4 v[236:239], v2, s[4:7], s50 offen offset:0 sc1
    v_cvt_pknorm_u16_f32 v152, v112, v113
    v_cvt_pknorm_u16_f32 v153, v114, v115
    v_add_u32 v144, s26, v152
    v_add_u32 v145, s26, v153
    v_pk_fmac_f16 v144, s27, v152
    v_pk_fmac_f16 v145, s27, v153
    v_mfma_f32_32x32x16_f16 v[48:63], v[200:203], v[148:151], v[48:63]
    s_mov_b64 exec, s[66:67]
    buffer_store_dwordx4 a[220:223], v255, s[4:7], s69 offen offset:512 sc1
    s_mov_b64 exec, -1
    v_cvt_pknorm_u16_f32 v152, v116, v117
    v_cvt_pknorm_u16_f32 v153, v118, v119
    v_add_u32 v146, s26, v152
    v_add_u32 v147, s26, v153
    v_pk_fmac_f16 v146, s27, v152
    v_pk_fmac_f16 v147, s27, v153
    v_mfma_f32_32x32x16_bf16 v[128:143], v[176:179], v[84:87], v[128:143]
    buffer_load_dwordx4 v[172:175], v1, s[4:7], s37 offen offset:0 sc1
    v_cvt_pknorm_u16_f32 v152, v120, v121
    v_cvt_pknorm_u16_f32 v153, v122, v123
    v_add_u32 v148, s26, v152
    v_add_u32 v149, s26, v153
    v_pk_fmac_f16 v148, s27, v152
    v_pk_fmac_f16 v149, s27, v153
    v_mfma_f32_32x32x16_f16 v[64:79], v[196:199], v[144:147], v[64:79]
    v_cvt_pknorm_u16_f32 v152, v124, v125
    v_cvt_pknorm_u16_f32 v153, v126, v127
    v_add_u32 v150, s26, v152
    v_add_u32 v151, s26, v153
    v_pk_fmac_f16 v150, s27, v152
    v_pk_fmac_f16 v151, s27, v153
    s_waitcnt vmcnt(18)
    v_mfma_f32_32x32x16_bf16 v[112:127], v[156:159], v[88:91], 0
    buffer_load_dwordx4 v[240:243], v2, s[4:7], s50 offen offset:1024 sc1
    v_cvt_pknorm_u16_f32 v152, v128, v129
    v_cvt_pknorm_u16_f32 v153, v130, v131
    v_add_u32 v144, s26, v152
    v_add_u32 v145, s26, v153
    v_pk_fmac_f16 v144, s27, v152
    v_pk_fmac_f16 v145, s27, v153
    v_mfma_f32_32x32x16_f16 v[64:79], v[200:203], v[148:151], v[64:79]
    v_cvt_pknorm_u16_f32 v152, v132, v133
    v_cvt_pknorm_u16_f32 v153, v134, v135
    v_add_u32 v146, s26, v152
    v_add_u32 v147, s26, v153
    v_pk_fmac_f16 v146, s27, v152
    v_pk_fmac_f16 v147, s27, v153
    v_mfma_f32_32x32x16_bf16 v[112:127], v[160:163], v[92:95], v[112:127]
    buffer_load_dwordx4 v[176:179], v1, s[4:7], s37 offen offset:1024 sc1
    v_cvt_pknorm_u16_f32 v152, v136, v137
    v_cvt_pknorm_u16_f32 v153, v138, v139
    v_add_u32 v148, s26, v152
    v_add_u32 v149, s26, v153
    v_pk_fmac_f16 v148, s27, v152
    v_pk_fmac_f16 v149, s27, v153
    v_mfma_f32_32x32x16_f16 v[16:31], v[196:199], v[144:147], v[16:31]
    v_cvt_pknorm_u16_f32 v152, v140, v141
    v_cvt_pknorm_u16_f32 v153, v142, v143
    v_add_u32 v150, s26, v152
    v_add_u32 v151, s26, v153
    v_pk_fmac_f16 v150, s27, v152
    v_pk_fmac_f16 v151, s27, v153
    v_mfma_f32_32x32x16_bf16 v[128:143], v[156:159], v[96:99], 0
    v_max3_u32 v3, v3, v156, v160
    buffer_load_dwordx4 v[244:247], v2, s[4:7], s50 offen offset:2048 sc1
    v_cvt_pknorm_u16_f32 v152, v112, v113
    v_cvt_pknorm_u16_f32 v153, v114, v115
    v_add_u32 v144, s26, v152
    v_add_u32 v145, s26, v153
    v_pk_fmac_f16 v144, s27, v152
    v_pk_fmac_f16 v145, s27, v153
    v_mfma_f32_32x32x16_f16 v[16:31], v[200:203], v[148:151], v[16:31]
    s_mov_b64 exec, s[66:67]
    buffer_store_dwordx4 a[224:227], v255, s[4:7], s70 offen offset:0 sc1
    s_mov_b64 exec, -1
    v_cvt_pknorm_u16_f32 v152, v116, v117
    v_cvt_pknorm_u16_f32 v153, v118, v119
    v_add_u32 v146, s26, v152
    v_add_u32 v147, s26, v153
    v_pk_fmac_f16 v146, s27, v152
    v_pk_fmac_f16 v147, s27, v153
    v_mfma_f32_32x32x16_bf16 v[128:143], v[160:163], v[100:103], v[128:143]
    buffer_load_dwordx4 v[196:199], v1, s[4:7], s37 offen offset:2048 sc1
    v_cvt_pknorm_u16_f32 v152, v120, v121
    v_cvt_pknorm_u16_f32 v153, v122, v123
    v_add_u32 v148, s26, v152
    v_add_u32 v149, s26, v153
    v_pk_fmac_f16 v148, s27, v152
    v_pk_fmac_f16 v149, s27, v153
    s_waitcnt vmcnt(18)
    v_mfma_f32_32x32x16_f16 v[32:47], v[180:183], v[144:147], v[32:47]
    v_cvt_pknorm_u16_f32 v152, v124, v125
    v_cvt_pknorm_u16_f32 v153, v126, v127
    v_add_u32 v150, s26, v152
    v_add_u32 v151, s26, v153
    v_pk_fmac_f16 v150, s27, v152
    v_pk_fmac_f16 v151, s27, v153
    v_mfma_f32_32x32x16_bf16 v[112:127], v[156:159], v[104:107], 0
    buffer_load_dwordx4 a[0:3], v2, s[4:7], s51 offen offset:1024 sc1
    v_cvt_pknorm_u16_f32 v152, v128, v129
    v_cvt_pknorm_u16_f32 v153, v130, v131
    v_add_u32 v144, s26, v152
    v_add_u32 v145, s26, v153
    v_pk_fmac_f16 v144, s27, v152
    v_pk_fmac_f16 v145, s27, v153
    v_mfma_f32_32x32x16_f16 v[32:47], v[184:187], v[148:151], v[32:47]
    v_cvt_pknorm_u16_f32 v152, v132, v133
    v_cvt_pknorm_u16_f32 v153, v134, v135
    v_add_u32 v146, s26, v152
    v_add_u32 v147, s26, v153
    v_pk_fmac_f16 v146, s27, v152
    v_pk_fmac_f16 v147, s27, v153
    v_mfma_f32_32x32x16_bf16 v[112:127], v[160:163], v[108:111], v[112:127]
    buffer_load_dwordx4 v[200:203], v1, s[4:7], s37 offen offset:3072 sc1
    v_cvt_pknorm_u16_f32 v152, v136, v137
    v_cvt_pknorm_u16_f32 v153, v138, v139
    v_add_u32 v148, s26, v152
    v_add_u32 v149, s26, v153
    v_pk_fmac_f16 v148, s27, v152
    v_pk_fmac_f16 v149, s27, v153
    v_mfma_f32_32x32x16_f16 v[48:63], v[180:183], v[144:147], v[48:63]
    v_cvt_pknorm_u16_f32 v152, v140, v141
    v_cvt_pknorm_u16_f32 v153, v142, v143
    v_add_u32 v150, s26, v152
    v_add_u32 v151, s26, v153
    v_pk_fmac_f16 v150, s27, v152
    v_pk_fmac_f16 v151, s27, v153
    v_mfma_f32_32x32x16_bf16 v[128:143], v[156:159], v[80:83], 0
    buffer_load_dwordx4 a[4:7], v2, s[4:7], s51 offen offset:2048 sc1
    v_cvt_pknorm_u16_f32 v152, v112, v113
    v_cvt_pknorm_u16_f32 v153, v114, v115
    v_add_u32 v144, s26, v152
    v_add_u32 v145, s26, v153
    v_pk_fmac_f16 v144, s27, v152
    v_pk_fmac_f16 v145, s27, v153
    v_mfma_f32_32x32x16_f16 v[48:63], v[184:187], v[148:151], v[48:63]
    s_mov_b64 exec, s[66:67]
    buffer_store_dwordx4 a[228:231], v255, s[4:7], s70 offen offset:512 sc1
    s_mov_b64 exec, -1
    v_cvt_pknorm_u16_f32 v152, v116, v117
    v_cvt_pknorm_u16_f32 v153, v118, v119
    v_add_u32 v146, s26, v152
    v_add_u32 v147, s26, v153
    v_pk_fmac_f16 v146, s27, v152
    v_pk_fmac_f16 v147, s27, v153
    v_mfma_f32_32x32x16_bf16 v[128:143], v[160:163], v[84:87], v[128:143]
    buffer_load_dwordx4 v[156:159], v1, s[4:7], s38 offen offset:0 sc1
    v_cvt_pknorm_u16_f32 v152, v120, v121
    v_cvt_pknorm_u16_f32 v153, v122, v123
    v_add_u32 v148, s26, v152
    v_add_u32 v149, s26, v153
    v_pk_fmac_f16 v148, s27, v152
    v_pk_fmac_f16 v149, s27, v153
    v_mfma_f32_32x32x16_f16 v[64:79], v[180:183], v[144:147], v[64:79]
    v_cvt_pknorm_u16_f32 v152, v124, v125
    v_cvt_pknorm_u16_f32 v153, v126, v127
    v_add_u32 v150, s26, v152
    v_add_u32 v151, s26, v153
    v_pk_fmac_f16 v150, s27, v152
    v_pk_fmac_f16 v151, s27, v153
    s_waitcnt vmcnt(18)
    v_mfma_f32_32x32x16_bf16 v[112:127], v[164:167], v[88:91], 0
    buffer_load_dwordx4 a[8:11], v2, s[4:7], s51 offen offset:3072 sc1
    v_cvt_pknorm_u16_f32 v152, v128, v129
    v_cvt_pknorm_u16_f32 v153, v130, v131
    v_add_u32 v144, s26, v152
    v_add_u32 v145, s26, v153
    v_pk_fmac_f16 v144, s27, v152
    v_pk_fmac_f16 v145, s27, v153
    v_mfma_f32_32x32x16_f16 v[64:79], v[184:187], v[148:151], v[64:79]
    v_cvt_pknorm_u16_f32 v152, v132, v133
    v_cvt_pknorm_u16_f32 v153, v134, v135
    v_add_u32 v146, s26, v152
    v_add_u32 v147, s26, v153
    v_pk_fmac_f16 v146, s27, v152
    v_pk_fmac_f16 v147, s27, v153
    v_mfma_f32_32x32x16_bf16 v[112:127], v[168:171], v[92:95], v[112:127]
    buffer_load_dwordx4 v[160:163], v1, s[4:7], s38 offen offset:1024 sc1
    v_cvt_pknorm_u16_f32 v152, v136, v137
    v_cvt_pknorm_u16_f32 v153, v138, v139
    v_add_u32 v148, s26, v152
    v_add_u32 v149, s26, v153
    v_pk_fmac_f16 v148, s27, v152
    v_pk_fmac_f16 v149, s27, v153
    v_mfma_f32_32x32x16_f16 v[16:31], v[180:183], v[144:147], v[16:31]
    v_cvt_pknorm_u16_f32 v152, v140, v141
    v_cvt_pknorm_u16_f32 v153, v142, v143
    v_add_u32 v150, s26, v152
    v_add_u32 v151, s26, v153
    v_pk_fmac_f16 v150, s27, v152
    v_pk_fmac_f16 v151, s27, v153
    v_mfma_f32_32x32x16_bf16 v[128:143], v[164:167], v[96:99], 0
    v_max3_u32 v3, v3, v164, v168
    buffer_load_dwordx4 a[12:15], v2, s[4:7], s52 offen offset:0 sc1
    v_cvt_pknorm_u16_f32 v152, v112, v113
    v_cvt_pknorm_u16_f32 v153, v114, v115
    v_add_u32 v144, s26, v152
    v_add_u32 v145, s26, v153
    v_pk_fmac_f16 v144, s27, v152
    v_pk_fmac_f16 v145, s27, v153
    v_mfma_f32_32x32x16_f16 v[16:31], v[184:187], v[148:151], v[16:31]
    s_mov_b64 exec, s[66:67]
    buffer_store_dwordx4 a[232:235], v255, s[4:7], s71 offen offset:0 sc1
    s_mov_b64 exec, -1
    v_cvt_pknorm_u16_f32 v152, v116, v117
    v_cvt_pknorm_u16_f32 v153, v118, v119
    v_add_u32 v146, s26, v152
    v_add_u32 v147, s26, v153
    v_pk_fmac_f16 v146, s27, v152
    v_pk_fmac_f16 v147, s27, v153
    v_mfma_f32_32x32x16_bf16 v[128:143], v[168:171], v[100:103], v[128:143]
    buffer_load_dwordx4 v[180:183], v1, s[4:7], s38 offen offset:2048 sc1
    v_cvt_pknorm_u16_f32 v152, v120, v121
    v_cvt_pknorm_u16_f32 v153, v122, v123
    v_add_u32 v148, s26, v152
    v_add_u32 v149, s26, v153
    v_pk_fmac_f16 v148, s27, v152
    v_pk_fmac_f16 v149, s27, v153
    s_waitcnt vmcnt(18)
    v_mfma_f32_32x32x16_f16 v[32:47], v[188:191], v[144:147], v[32:47]
    v_cvt_pknorm_u16_f32 v152, v124, v125
    v_cvt_pknorm_u16_f32 v153, v126, v127
    v_add_u32 v150, s26, v152
    v_add_u32 v151, s26, v153
    v_pk_fmac_f16 v150, s27, v152
    v_pk_fmac_f16 v151, s27, v153
    v_mfma_f32_32x32x16_bf16 v[112:127], v[164:167], v[104:107], 0
    buffer_load_dwordx4 a[16:19], v2, s[4:7], s52 offen offset:1024 sc1
    v_cvt_pknorm_u16_f32 v152, v128, v129
    v_cvt_pknorm_u16_f32 v153, v130, v131
    v_add_u32 v144, s26, v152
    v_add_u32 v145, s26, v153
    v_pk_fmac_f16 v144, s27, v152
    v_pk_fmac_f16 v145, s27, v153
    v_mfma_f32_32x32x16_f16 v[32:47], v[192:195], v[148:151], v[32:47]
    v_cvt_pknorm_u16_f32 v152, v132, v133
    v_cvt_pknorm_u16_f32 v153, v134, v135
    v_add_u32 v146, s26, v152
    v_add_u32 v147, s26, v153
    v_pk_fmac_f16 v146, s27, v152
    v_pk_fmac_f16 v147, s27, v153
    v_mfma_f32_32x32x16_bf16 v[112:127], v[168:171], v[108:111], v[112:127]
    buffer_load_dwordx4 v[184:187], v1, s[4:7], s38 offen offset:3072 sc1
    v_cvt_pknorm_u16_f32 v152, v136, v137
    v_cvt_pknorm_u16_f32 v153, v138, v139
    v_add_u32 v148, s26, v152
    v_add_u32 v149, s26, v153
    v_pk_fmac_f16 v148, s27, v152
    v_pk_fmac_f16 v149, s27, v153
    v_mfma_f32_32x32x16_f16 v[48:63], v[188:191], v[144:147], v[48:63]
    v_cvt_pknorm_u16_f32 v152, v140, v141
    v_cvt_pknorm_u16_f32 v153, v142, v143
    v_add_u32 v150, s26, v152
    v_add_u32 v151, s26, v153
    v_pk_fmac_f16 v150, s27, v152
    v_pk_fmac_f16 v151, s27, v153
    v_mfma_f32_32x32x16_bf16 v[128:143], v[164:167], v[80:83], 0
    buffer_load_dwordx4 a[20:23], v2, s[4:7], s52 offen offset:2048 sc1
    v_cvt_pknorm_u16_f32 v152, v112, v113
    v_cvt_pknorm_u16_f32 v153, v114, v115
    v_add_u32 v144, s26, v152
    v_add_u32 v145, s26, v153
    v_pk_fmac_f16 v144, s27, v152
    v_pk_fmac_f16 v145, s27, v153
    v_mfma_f32_32x32x16_f16 v[48:63], v[192:195], v[148:151], v[48:63]
    s_mov_b64 exec, s[66:67]
    buffer_store_dwordx4 a[236:239], v255, s[4:7], s71 offen offset:512 sc1
    s_mov_b64 exec, -1
    v_cvt_pknorm_u16_f32 v152, v116, v117
    v_cvt_pknorm_u16_f32 v153, v118, v119
    v_add_u32 v146, s26, v152
    v_add_u32 v147, s26, v153
    v_pk_fmac_f16 v146, s27, v152
    v_pk_fmac_f16 v147, s27, v153
    v_mfma_f32_32x32x16_bf16 v[128:143], v[168:171], v[84:87], v[128:143]
    buffer_load_dwordx4 v[164:167], v1, s[4:7], s39 offen offset:0 sc1
    v_cvt_pknorm_u16_f32 v152, v120, v121
    v_cvt_pknorm_u16_f32 v153, v122, v123
    v_add_u32 v148, s26, v152
    v_add_u32 v149, s26, v153
    v_pk_fmac_f16 v148, s27, v152
    v_pk_fmac_f16 v149, s27, v153
    v_mfma_f32_32x32x16_f16 v[64:79], v[188:191], v[144:147], v[64:79]
    v_cvt_pknorm_u16_f32 v152, v124, v125
    v_cvt_pknorm_u16_f32 v153, v126, v127
    v_add_u32 v150, s26, v152
    v_add_u32 v151, s26, v153
    v_pk_fmac_f16 v150, s27, v152
    v_pk_fmac_f16 v151, s27, v153
    s_waitcnt vmcnt(18)
    v_mfma_f32_32x32x16_bf16 v[112:127], v[172:175], v[88:91], 0
    buffer_load_dwordx4 a[24:27], v2, s[4:7], s52 offen offset:3072 sc1
    v_cvt_pknorm_u16_f32 v152, v128, v129
    v_cvt_pknorm_u16_f32 v153, v130, v131
    v_add_u32 v144, s26, v152
    v_add_u32 v145, s26, v153
    v_pk_fmac_f16 v144, s27, v152
    v_pk_fmac_f16 v145, s27, v153
    v_mfma_f32_32x32x16_f16 v[64:79], v[192:195], v[148:151], v[64:79]
    v_cvt_pknorm_u16_f32 v152, v132, v133
    v_cvt_pknorm_u16_f32 v153, v134, v135
    v_add_u32 v146, s26, v152
    v_add_u32 v147, s26, v153
    v_pk_fmac_f16 v146, s27, v152
    v_pk_fmac_f16 v147, s27, v153
    v_mfma_f32_32x32x16_bf16 v[112:127], v[176:179], v[92:95], v[112:127]
    buffer_load_dwordx4 v[168:171], v1, s[4:7], s39 offen offset:1024 sc1
    v_cvt_pknorm_u16_f32 v152, v136, v137
    v_cvt_pknorm_u16_f32 v153, v138, v139
    v_add_u32 v148, s26, v152
    v_add_u32 v149, s26, v153
    v_pk_fmac_f16 v148, s27, v152
    v_pk_fmac_f16 v149, s27, v153
    v_mfma_f32_32x32x16_f16 v[16:31], v[188:191], v[144:147], v[16:31]
    v_cvt_pknorm_u16_f32 v152, v140, v141
    v_cvt_pknorm_u16_f32 v153, v142, v143
    v_add_u32 v150, s26, v152
    v_add_u32 v151, s26, v153
    v_pk_fmac_f16 v150, s27, v152
    v_pk_fmac_f16 v151, s27, v153
    v_mfma_f32_32x32x16_bf16 v[128:143], v[172:175], v[96:99], 0
    v_max3_u32 v3, v3, v172, v176
    buffer_load_dwordx4 a[28:31], v2, s[4:7], s53 offen offset:0 sc1
    v_cvt_pknorm_u16_f32 v152, v112, v113
    v_cvt_pknorm_u16_f32 v153, v114, v115
    v_add_u32 v144, s26, v152
    v_add_u32 v145, s26, v153
    v_pk_fmac_f16 v144, s27, v152
    v_pk_fmac_f16 v145, s27, v153
    v_mfma_f32_32x32x16_f16 v[16:31], v[192:195], v[148:151], v[16:31]
    s_mov_b64 exec, s[64:65]
    global_store_dwordx4 v251, a[204:207], s[14:15] sc1
    s_mov_b64 exec, -1
    v_cvt_pknorm_u16_f32 v152, v116, v117
    v_cvt_pknorm_u16_f32 v153, v118, v119
    v_add_u32 v146, s26, v152
    v_add_u32 v147, s26, v153
    v_pk_fmac_f16 v146, s27, v152
    v_pk_fmac_f16 v147, s27, v153
    v_mfma_f32_32x32x16_bf16 v[128:143], v[176:179], v[100:103], v[128:143]
    buffer_load_dwordx4 v[188:191], v1, s[4:7], s39 offen offset:2048 sc1
    v_cvt_pknorm_u16_f32 v152, v120, v121
    v_cvt_pknorm_u16_f32 v153, v122, v123
    v_add_u32 v148, s26, v152
    v_add_u32 v149, s26, v153
    v_pk_fmac_f16 v148, s27, v152
    v_pk_fmac_f16 v149, s27, v153
    s_waitcnt vmcnt(18)
    v_mfma_f32_32x32x16_f16 v[32:47], v[196:199], v[144:147], v[32:47]
    v_cvt_pknorm_u16_f32 v152, v124, v125
    v_cvt_pknorm_u16_f32 v153, v126, v127
    v_add_u32 v150, s26, v152
    v_add_u32 v151, s26, v153
    v_pk_fmac_f16 v150, s27, v152
    v_pk_fmac_f16 v151, s27, v153
    v_mfma_f32_32x32x16_bf16 v[112:127], v[172:175], v[104:107], 0
    buffer_load_dwordx4 v[248:251], v2, s[4:7], s50 offen offset:3072 sc1
    v_cvt_pknorm_u16_f32 v152, v128, v129
    v_cvt_pknorm_u16_f32 v153, v130, v131
    v_add_u32 v144, s26, v152
    v_add_u32 v145, s26, v153
    v_pk_fmac_f16 v144, s27, v152
    v_pk_fmac_f16 v145, s27, v153
    v_mfma_f32_32x32x16_f16 v[32:47], v[200:203], v[148:151], v[32:47]
    v_cvt_pknorm_u16_f32 v152, v132, v133
    v_cvt_pknorm_u16_f32 v153, v134, v135
    v_add_u32 v146, s26, v152
    v_add_u32 v147, s26, v153
    v_pk_fmac_f16 v146, s27, v152
    v_pk_fmac_f16 v147, s27, v153
    v_mfma_f32_32x32x16_bf16 v[112:127], v[176:179], v[108:111], v[112:127]
    buffer_load_dwordx4 v[192:195], v1, s[4:7], s39 offen offset:3072 sc1
    v_cvt_pknorm_u16_f32 v152, v136, v137
    v_cvt_pknorm_u16_f32 v153, v138, v139
    v_add_u32 v148, s26, v152
    v_add_u32 v149, s26, v153
    v_pk_fmac_f16 v148, s27, v152
    v_pk_fmac_f16 v149, s27, v153
    v_mfma_f32_32x32x16_f16 v[48:63], v[196:199], v[144:147], v[48:63]
    v_cvt_pknorm_u16_f32 v152, v140, v141
    v_cvt_pknorm_u16_f32 v153, v142, v143
    v_add_u32 v150, s26, v152
    v_add_u32 v151, s26, v153
    v_pk_fmac_f16 v150, s27, v152
    v_pk_fmac_f16 v151, s27, v153
    v_mfma_f32_32x32x16_bf16 v[128:143], v[172:175], v[80:83], 0
    buffer_load_dwordx4 v[252:255], v2, s[4:7], s51 offen offset:0 sc1
    v_cvt_pknorm_u16_f32 v152, v112, v113
    v_cvt_pknorm_u16_f32 v153, v114, v115
    v_add_u32 v144, s26, v152
    v_add_u32 v145, s26, v153
    v_pk_fmac_f16 v144, s27, v152
    v_pk_fmac_f16 v145, s27, v153
    v_mfma_f32_32x32x16_f16 v[48:63], v[200:203], v[148:151], v[48:63]
    v_cvt_pknorm_u16_f32 v152, v116, v117
    v_cvt_pknorm_u16_f32 v153, v118, v119
    v_add_u32 v146, s26, v152
    v_add_u32 v147, s26, v153
    v_pk_fmac_f16 v146, s27, v152
    v_pk_fmac_f16 v147, s27, v153
    v_mfma_f32_32x32x16_bf16 v[128:143], v[176:179], v[84:87], v[128:143]
    buffer_load_dwordx4 v[172:175], v1, s[4:7], s40 offen offset:0 sc1
    v_cvt_pknorm_u16_f32 v152, v120, v121
    v_cvt_pknorm_u16_f32 v153, v122, v123
    v_add_u32 v148, s26, v152
    v_add_u32 v149, s26, v153
    v_pk_fmac_f16 v148, s27, v152
    v_pk_fmac_f16 v149, s27, v153
    v_mfma_f32_32x32x16_f16 v[64:79], v[196:199], v[144:147], v[64:79]
    v_cvt_pknorm_u16_f32 v152, v124, v125
    v_cvt_pknorm_u16_f32 v153, v126, v127
    v_add_u32 v150, s26, v152
    v_add_u32 v151, s26, v153
    v_pk_fmac_f16 v150, s27, v152
    v_pk_fmac_f16 v151, s27, v153
    s_waitcnt vmcnt(17)
    v_mfma_f32_32x32x16_bf16 v[112:127], v[156:159], v[88:91], 0
    buffer_load_dwordx4 a[32:35], v2, s[4:7], s53 offen offset:1024 sc1
    v_cvt_pknorm_u16_f32 v152, v128, v129
    v_cvt_pknorm_u16_f32 v153, v130, v131
    v_add_u32 v144, s26, v152
    v_add_u32 v145, s26, v153
    v_pk_fmac_f16 v144, s27, v152
    v_pk_fmac_f16 v145, s27, v153
    v_mfma_f32_32x32x16_f16 v[64:79], v[200:203], v[148:151], v[64:79]
    v_cvt_pknorm_u16_f32 v152, v132, v133
    v_cvt_pknorm_u16_f32 v153, v134, v135
    v_add_u32 v146, s26, v152
    v_add_u32 v147, s26, v153
    v_pk_fmac_f16 v146, s27, v152
    v_pk_fmac_f16 v147, s27, v153
    v_mfma_f32_32x32x16_bf16 v[112:127], v[160:163], v[92:95], v[112:127]
    buffer_load_dwordx4 v[176:179], v1, s[4:7], s40 offen offset:1024 sc1
    v_cvt_pknorm_u16_f32 v152, v136, v137
    v_cvt_pknorm_u16_f32 v153, v138, v139
    v_add_u32 v148, s26, v152
    v_add_u32 v149, s26, v153
    v_pk_fmac_f16 v148, s27, v152
    v_pk_fmac_f16 v149, s27, v153
    v_mfma_f32_32x32x16_f16 v[16:31], v[196:199], v[144:147], v[16:31]
    v_cvt_pknorm_u16_f32 v152, v140, v141
    v_cvt_pknorm_u16_f32 v153, v142, v143
    v_add_u32 v150, s26, v152
    v_add_u32 v151, s26, v153
    v_pk_fmac_f16 v150, s27, v152
    v_pk_fmac_f16 v151, s27, v153
    v_mfma_f32_32x32x16_bf16 v[128:143], v[156:159], v[96:99], 0
    v_max3_u32 v3, v3, v156, v160
    buffer_load_dwordx4 a[36:39], v2, s[4:7], s53 offen offset:2048 sc1
    v_cvt_pknorm_u16_f32 v152, v112, v113
    v_cvt_pknorm_u16_f32 v153, v114, v115
    v_add_u32 v144, s26, v152
    v_add_u32 v145, s26, v153
    v_pk_fmac_f16 v144, s27, v152
    v_pk_fmac_f16 v145, s27, v153
    v_mfma_f32_32x32x16_f16 v[16:31], v[200:203], v[148:151], v[16:31]
    v_cvt_pknorm_u16_f32 v152, v116, v117
    v_cvt_pknorm_u16_f32 v153, v118, v119
    v_add_u32 v146, s26, v152
    v_add_u32 v147, s26, v153
    v_pk_fmac_f16 v146, s27, v152
    v_pk_fmac_f16 v147, s27, v153
    v_mfma_f32_32x32x16_bf16 v[128:143], v[160:163], v[100:103], v[128:143]
    buffer_load_dwordx4 v[196:199], v1, s[4:7], s40 offen offset:2048 sc1
    v_cvt_pknorm_u16_f32 v152, v120, v121
    v_cvt_pknorm_u16_f32 v153, v122, v123
    v_add_u32 v148, s26, v152
    v_add_u32 v149, s26, v153
    v_pk_fmac_f16 v148, s27, v152
    v_pk_fmac_f16 v149, s27, v153
    s_waitcnt vmcnt(16)
    v_mfma_f32_32x32x16_f16 v[32:47], v[180:183], v[144:147], v[32:47]
    v_cvt_pknorm_u16_f32 v152, v124, v125
    v_cvt_pknorm_u16_f32 v153, v126, v127
    v_add_u32 v150, s26, v152
    v_add_u32 v151, s26, v153
    v_pk_fmac_f16 v150, s27, v152
    v_pk_fmac_f16 v151, s27, v153
    v_mfma_f32_32x32x16_bf16 v[112:127], v[156:159], v[104:107], 0
    buffer_load_dwordx4 a[40:43], v2, s[4:7], s53 offen offset:3072 sc1
    v_cvt_pknorm_u16_f32 v152, v128, v129
    v_cvt_pknorm_u16_f32 v153, v130, v131
    v_add_u32 v144, s26, v152
    v_add_u32 v145, s26, v153
    v_pk_fmac_f16 v144, s27, v152
    v_pk_fmac_f16 v145, s27, v153
    v_mfma_f32_32x32x16_f16 v[32:47], v[184:187], v[148:151], v[32:47]
    v_cvt_pknorm_u16_f32 v152, v132, v133
    v_cvt_pknorm_u16_f32 v153, v134, v135
    v_add_u32 v146, s26, v152
    v_add_u32 v147, s26, v153
    v_pk_fmac_f16 v146, s27, v152
    v_pk_fmac_f16 v147, s27, v153
    v_mfma_f32_32x32x16_bf16 v[112:127], v[160:163], v[108:111], v[112:127]
    buffer_load_dwordx4 v[200:203], v1, s[4:7], s40 offen offset:3072 sc1
    v_cvt_pknorm_u16_f32 v152, v136, v137
    v_cvt_pknorm_u16_f32 v153, v138, v139
    v_add_u32 v148, s26, v152
    v_add_u32 v149, s26, v153
    v_pk_fmac_f16 v148, s27, v152
    v_pk_fmac_f16 v149, s27, v153
    v_mfma_f32_32x32x16_f16 v[48:63], v[180:183], v[144:147], v[48:63]
    v_cvt_pknorm_u16_f32 v152, v140, v141
    v_cvt_pknorm_u16_f32 v153, v142, v143
    v_add_u32 v150, s26, v152
    v_add_u32 v151, s26, v153
    v_pk_fmac_f16 v150, s27, v152
    v_pk_fmac_f16 v151, s27, v153
    v_mfma_f32_32x32x16_bf16 v[128:143], v[156:159], v[80:83], 0
    buffer_load_dwordx4 a[44:47], v2, s[4:7], s54 offen offset:0 sc1
    v_cvt_pknorm_u16_f32 v152, v112, v113
    v_cvt_pknorm_u16_f32 v153, v114, v115
    v_add_u32 v144, s26, v152
    v_add_u32 v145, s26, v153
    v_pk_fmac_f16 v144, s27, v152
    v_pk_fmac_f16 v145, s27, v153
    v_mfma_f32_32x32x16_f16 v[48:63], v[184:187], v[148:151], v[48:63]
    v_cvt_pknorm_u16_f32 v152, v116, v117
    v_cvt_pknorm_u16_f32 v153, v118, v119
    v_add_u32 v146, s26, v152
    v_add_u32 v147, s26, v153
    v_pk_fmac_f16 v146, s27, v152
    v_pk_fmac_f16 v147, s27, v153
    v_mfma_f32_32x32x16_bf16 v[128:143], v[160:163], v[84:87], v[128:143]
    buffer_load_dwordx4 v[156:159], v1, s[4:7], s41 offen offset:0 sc1
    v_cvt_pknorm_u16_f32 v152, v120, v121
    v_cvt_pknorm_u16_f32 v153, v122, v123
    v_add_u32 v148, s26, v152
    v_add_u32 v149, s26, v153
    v_pk_fmac_f16 v148, s27, v152
    v_pk_fmac_f16 v149, s27, v153
    v_mfma_f32_32x32x16_f16 v[64:79], v[180:183], v[144:147], v[64:79]
    v_cvt_pknorm_u16_f32 v152, v124, v125
    v_cvt_pknorm_u16_f32 v153, v126, v127
    v_add_u32 v150, s26, v152
    v_add_u32 v151, s26, v153
    v_pk_fmac_f16 v150, s27, v152
    v_pk_fmac_f16 v151, s27, v153
    s_waitcnt vmcnt(15)
    v_mfma_f32_32x32x16_bf16 v[112:127], v[164:167], v[88:91], 0
    buffer_load_dwordx4 a[48:51], v2, s[4:7], s54 offen offset:1024 sc1
    v_cvt_pknorm_u16_f32 v152, v128, v129
    v_cvt_pknorm_u16_f32 v153, v130, v131
    v_add_u32 v144, s26, v152
    v_add_u32 v145, s26, v153
    v_pk_fmac_f16 v144, s27, v152
    v_pk_fmac_f16 v145, s27, v153
    v_mfma_f32_32x32x16_f16 v[64:79], v[184:187], v[148:151], v[64:79]
    v_cvt_pknorm_u16_f32 v152, v132, v133
    v_cvt_pknorm_u16_f32 v153, v134, v135
    v_add_u32 v146, s26, v152
    v_add_u32 v147, s26, v153
    v_pk_fmac_f16 v146, s27, v152
    v_pk_fmac_f16 v147, s27, v153
    v_mfma_f32_32x32x16_bf16 v[112:127], v[168:171], v[92:95], v[112:127]
    buffer_load_dwordx4 v[160:163], v1, s[4:7], s41 offen offset:1024 sc1
    v_cvt_pknorm_u16_f32 v152, v136, v137
    v_cvt_pknorm_u16_f32 v153, v138, v139
    v_add_u32 v148, s26, v152
    v_add_u32 v149, s26, v153
    v_pk_fmac_f16 v148, s27, v152
    v_pk_fmac_f16 v149, s27, v153
    v_mfma_f32_32x32x16_f16 v[16:31], v[180:183], v[144:147], v[16:31]
    v_cvt_pknorm_u16_f32 v152, v140, v141
    v_cvt_pknorm_u16_f32 v153, v142, v143
    v_add_u32 v150, s26, v152
    v_add_u32 v151, s26, v153
    v_pk_fmac_f16 v150, s27, v152
    v_pk_fmac_f16 v151, s27, v153
    v_mfma_f32_32x32x16_bf16 v[128:143], v[164:167], v[96:99], 0
    v_max3_u32 v3, v3, v164, v168
    buffer_load_dwordx4 a[52:55], v2, s[4:7], s54 offen offset:2048 sc1
    v_cvt_pknorm_u16_f32 v152, v112, v113
    v_cvt_pknorm_u16_f32 v153, v114, v115
    v_add_u32 v144, s26, v152
    v_add_u32 v145, s26, v153
    v_pk_fmac_f16 v144, s27, v152
    v_pk_fmac_f16 v145, s27, v153
    v_mfma_f32_32x32x16_f16 v[16:31], v[184:187], v[148:151], v[16:31]
    v_cvt_pknorm_u16_f32 v152, v116, v117
    v_cvt_pknorm_u16_f32 v153, v118, v119
    v_add_u32 v146, s26, v152
    v_add_u32 v147, s26, v153
    v_pk_fmac_f16 v146, s27, v152
    v_pk_fmac_f16 v147, s27, v153
    v_mfma_f32_32x32x16_bf16 v[128:143], v[168:171], v[100:103], v[128:143]
    buffer_load_dwordx4 v[180:183], v1, s[4:7], s41 offen offset:2048 sc1
    v_cvt_pknorm_u16_f32 v152, v120, v121
    v_cvt_pknorm_u16_f32 v153, v122, v123
    v_add_u32 v148, s26, v152
    v_add_u32 v149, s26, v153
    v_pk_fmac_f16 v148, s27, v152
    v_pk_fmac_f16 v149, s27, v153
    s_waitcnt vmcnt(14)
    v_mfma_f32_32x32x16_f16 v[32:47], v[188:191], v[144:147], v[32:47]
    v_cvt_pknorm_u16_f32 v152, v124, v125
    v_cvt_pknorm_u16_f32 v153, v126, v127
    v_add_u32 v150, s26, v152
    v_add_u32 v151, s26, v153
    v_pk_fmac_f16 v150, s27, v152
    v_pk_fmac_f16 v151, s27, v153
    v_mfma_f32_32x32x16_bf16 v[112:127], v[164:167], v[104:107], 0
    buffer_load_dwordx4 a[56:59], v2, s[4:7], s54 offen offset:3072 sc1
    v_cvt_pknorm_u16_f32 v152, v128, v129
    v_cvt_pknorm_u16_f32 v153, v130, v131
    v_add_u32 v144, s26, v152
    v_add_u32 v145, s26, v153
    v_pk_fmac_f16 v144, s27, v152
    v_pk_fmac_f16 v145, s27, v153
    v_mfma_f32_32x32x16_f16 v[32:47], v[192:195], v[148:151], v[32:47]
    v_cvt_pknorm_u16_f32 v152, v132, v133
    v_cvt_pknorm_u16_f32 v153, v134, v135
    v_add_u32 v146, s26, v152
    v_add_u32 v147, s26, v153
    v_pk_fmac_f16 v146, s27, v152
    v_pk_fmac_f16 v147, s27, v153
    v_mfma_f32_32x32x16_bf16 v[112:127], v[168:171], v[108:111], v[112:127]
    buffer_load_dwordx4 v[184:187], v1, s[4:7], s41 offen offset:3072 sc1
    v_cvt_pknorm_u16_f32 v152, v136, v137
    v_cvt_pknorm_u16_f32 v153, v138, v139
    v_add_u32 v148, s26, v152
    v_add_u32 v149, s26, v153
    v_pk_fmac_f16 v148, s27, v152
    v_pk_fmac_f16 v149, s27, v153
    v_mfma_f32_32x32x16_f16 v[48:63], v[188:191], v[144:147], v[48:63]
    v_cvt_pknorm_u16_f32 v152, v140, v141
    v_cvt_pknorm_u16_f32 v153, v142, v143
    v_add_u32 v150, s26, v152
    v_add_u32 v151, s26, v153
    v_pk_fmac_f16 v150, s27, v152
    v_pk_fmac_f16 v151, s27, v153
    v_mfma_f32_32x32x16_bf16 v[128:143], v[164:167], v[80:83], 0
    buffer_load_dwordx4 a[60:63], v2, s[4:7], s55 offen offset:0 sc1
    v_cvt_pknorm_u16_f32 v152, v112, v113
    v_cvt_pknorm_u16_f32 v153, v114, v115
    v_add_u32 v144, s26, v152
    v_add_u32 v145, s26, v153
    v_pk_fmac_f16 v144, s27, v152
    v_pk_fmac_f16 v145, s27, v153
    v_mfma_f32_32x32x16_f16 v[48:63], v[192:195], v[148:151], v[48:63]
    v_mov_b32 v14, s12
    v_mov_b32 v15, s13
    s_cmp_lg_u32 s79, 0
    s_cselect_b64 exec, 1, 0
    buffer_store_dwordx2 v[14:15], off, s[4:7], s79 sc1
    s_mov_b64 exec, -1
    v_cvt_pknorm_u16_f32 v152, v116, v117
    v_cvt_pknorm_u16_f32 v153, v118, v119
    v_add_u32 v146, s26, v152
    v_add_u32 v147, s26, v153
    v_pk_fmac_f16 v146, s27, v152
    v_pk_fmac_f16 v147, s27, v153
    v_mfma_f32_32x32x16_bf16 v[128:143], v[168:171], v[84:87], v[128:143]
    buffer_load_dwordx4 v[164:167], v1, s[4:7], s42 offen offset:0 sc1
    v_cvt_pknorm_u16_f32 v152, v120, v121
    v_cvt_pknorm_u16_f32 v153, v122, v123
    v_add_u32 v148, s26, v152
    v_add_u32 v149, s26, v153
    v_pk_fmac_f16 v148, s27, v152
    v_pk_fmac_f16 v149, s27, v153
    v_mfma_f32_32x32x16_f16 v[64:79], v[188:191], v[144:147], v[64:79]
    v_cvt_pknorm_u16_f32 v152, v124, v125
    v_cvt_pknorm_u16_f32 v153, v126, v127
    v_add_u32 v150, s26, v152
    v_add_u32 v151, s26, v153
    v_pk_fmac_f16 v150, s27, v152
    v_pk_fmac_f16 v151, s27, v153
    s_waitcnt vmcnt(15)
    v_mfma_f32_32x32x16_bf16 v[112:127], v[172:175], v[88:91], 0
    buffer_load_dwordx4 a[64:67], v2, s[4:7], s55 offen offset:1024 sc1
    v_cvt_pknorm_u16_f32 v152, v128, v129
    v_cvt_pknorm_u16_f32 v153, v130, v131
    v_add_u32 v144, s26, v152
    v_add_u32 v145, s26, v153
    v_pk_fmac_f16 v144, s27, v152
    v_pk_fmac_f16 v145, s27, v153
    v_mfma_f32_32x32x16_f16 v[64:79], v[192:195], v[148:151], v[64:79]
    s_mov_b32 s64, 0xc90000
    v_cvt_pknorm_u16_f32 v152, v132, v133
    v_cvt_pknorm_u16_f32 v153, v134, v135
    v_add_u32 v146, s26, v152
    v_add_u32 v147, s26, v153
    v_pk_fmac_f16 v146, s27, v152
    v_pk_fmac_f16 v147, s27, v153
    v_mfma_f32_32x32x16_bf16 v[112:127], v[176:179], v[92:95], v[112:127]
    buffer_load_dwordx4 v[168:171], v1, s[4:7], s42 offen offset:1024 sc1
    v_cvt_pknorm_u16_f32 v152, v136, v137
    v_cvt_pknorm_u16_f32 v153, v138, v139
    v_add_u32 v148, s26, v152
    v_add_u32 v149, s26, v153
    v_pk_fmac_f16 v148, s27, v152
    v_pk_fmac_f16 v149, s27, v153
    v_mfma_f32_32x32x16_f16 v[16:31], v[188:191], v[144:147], v[16:31]
    s_mov_b32 s65, 0xc91000
    v_cvt_pknorm_u16_f32 v152, v140, v141
    v_cvt_pknorm_u16_f32 v153, v142, v143
    v_add_u32 v150, s26, v152
    v_add_u32 v151, s26, v153
    v_pk_fmac_f16 v150, s27, v152
    v_pk_fmac_f16 v151, s27, v153
    v_mfma_f32_32x32x16_bf16 v[128:143], v[172:175], v[96:99], 0
    v_max3_u32 v3, v3, v172, v176
    buffer_load_dwordx4 a[68:71], v2, s[4:7], s55 offen offset:2048 sc1
    v_cvt_pknorm_u16_f32 v152, v112, v113
    v_cvt_pknorm_u16_f32 v153, v114, v115
    v_add_u32 v144, s26, v152
    v_add_u32 v145, s26, v153
    v_pk_fmac_f16 v144, s27, v152
    v_pk_fmac_f16 v145, s27, v153
    v_mfma_f32_32x32x16_f16 v[16:31], v[192:195], v[148:151], v[16:31]
    s_mov_b32 s66, 0xc92000
    v_cvt_pknorm_u16_f32 v152, v116, v117
    v_cvt_pknorm_u16_f32 v153, v118, v119
    v_add_u32 v146, s26, v152
    v_add_u32 v147, s26, v153
    v_pk_fmac_f16 v146, s27, v152
    v_pk_fmac_f16 v147, s27, v153
    v_mfma_f32_32x32x16_bf16 v[128:143], v[176:179], v[100:103], v[128:143]
    buffer_load_dwordx4 v[188:191], v1, s[4:7], s42 offen offset:2048 sc1
    v_cvt_pknorm_u16_f32 v152, v120, v121
    v_cvt_pknorm_u16_f32 v153, v122, v123
    v_add_u32 v148, s26, v152
    v_add_u32 v149, s26, v153
    v_pk_fmac_f16 v148, s27, v152
    v_pk_fmac_f16 v149, s27, v153
    s_waitcnt vmcnt(15)
    v_mfma_f32_32x32x16_f16 v[32:47], v[196:199], v[144:147], v[32:47]
    s_mov_b32 s67, 0xc93000
    v_cvt_pknorm_u16_f32 v152, v124, v125
    v_cvt_pknorm_u16_f32 v153, v126, v127
    v_add_u32 v150, s26, v152
    v_add_u32 v151, s26, v153
    v_pk_fmac_f16 v150, s27, v152
    v_pk_fmac_f16 v151, s27, v153
    v_mfma_f32_32x32x16_bf16 v[112:127], v[172:175], v[104:107], 0
    buffer_load_dwordx4 a[72:75], v2, s[4:7], s55 offen offset:3072 sc1
    v_cvt_pknorm_u16_f32 v152, v128, v129
    v_cvt_pknorm_u16_f32 v153, v130, v131
    v_add_u32 v144, s26, v152
    v_add_u32 v145, s26, v153
    v_pk_fmac_f16 v144, s27, v152
    v_pk_fmac_f16 v145, s27, v153
    v_mfma_f32_32x32x16_f16 v[32:47], v[200:203], v[148:151], v[32:47]
    s_mov_b32 s68, 0xc94000
    v_cvt_pknorm_u16_f32 v152, v132, v133
    v_cvt_pknorm_u16_f32 v153, v134, v135
    v_add_u32 v146, s26, v152
    v_add_u32 v147, s26, v153
    v_pk_fmac_f16 v146, s27, v152
    v_pk_fmac_f16 v147, s27, v153
    v_mfma_f32_32x32x16_bf16 v[112:127], v[176:179], v[108:111], v[112:127]
    buffer_load_dwordx4 v[192:195], v1, s[4:7], s42 offen offset:3072 sc1
    v_cvt_pknorm_u16_f32 v152, v136, v137
    v_cvt_pknorm_u16_f32 v153, v138, v139
    v_add_u32 v148, s26, v152
    v_add_u32 v149, s26, v153
    v_pk_fmac_f16 v148, s27, v152
    v_pk_fmac_f16 v149, s27, v153
    v_mfma_f32_32x32x16_f16 v[48:63], v[196:199], v[144:147], v[48:63]
    s_mov_b32 s69, 0xc95000
    v_cvt_pknorm_u16_f32 v152, v140, v141
    v_cvt_pknorm_u16_f32 v153, v142, v143
    v_add_u32 v150, s26, v152
    v_add_u32 v151, s26, v153
    v_pk_fmac_f16 v150, s27, v152
    v_pk_fmac_f16 v151, s27, v153
    v_mfma_f32_32x32x16_bf16 v[128:143], v[172:175], v[80:83], 0
    buffer_load_dwordx4 a[76:79], v2, s[4:7], s56 offen offset:0 sc1
    v_cvt_pknorm_u16_f32 v152, v112, v113
    v_cvt_pknorm_u16_f32 v153, v114, v115
    v_add_u32 v144, s26, v152
    v_add_u32 v145, s26, v153
    v_pk_fmac_f16 v144, s27, v152
    v_pk_fmac_f16 v145, s27, v153
    v_mfma_f32_32x32x16_f16 v[48:63], v[200:203], v[148:151], v[48:63]
    s_mov_b32 s70, 0xc96000
    v_cvt_pknorm_u16_f32 v152, v116, v117
    v_cvt_pknorm_u16_f32 v153, v118, v119
    v_add_u32 v146, s26, v152
    v_add_u32 v147, s26, v153
    v_pk_fmac_f16 v146, s27, v152
    v_pk_fmac_f16 v147, s27, v153
    v_mfma_f32_32x32x16_bf16 v[128:143], v[176:179], v[84:87], v[128:143]
    buffer_load_dwordx4 v[172:175], v1, s[4:7], s43 offen offset:0 sc1
    v_cvt_pknorm_u16_f32 v152, v120, v121
    v_cvt_pknorm_u16_f32 v153, v122, v123
    v_add_u32 v148, s26, v152
    v_add_u32 v149, s26, v153
    v_pk_fmac_f16 v148, s27, v152
    v_pk_fmac_f16 v149, s27, v153
    v_mfma_f32_32x32x16_f16 v[64:79], v[196:199], v[144:147], v[64:79]
    s_mov_b32 s71, 0xc97000
    v_cvt_pknorm_u16_f32 v152, v124, v125
    v_cvt_pknorm_u16_f32 v153, v126, v127
    v_add_u32 v150, s26, v152
    v_add_u32 v151, s26, v153
    v_pk_fmac_f16 v150, s27, v152
    v_pk_fmac_f16 v151, s27, v153
    s_waitcnt vmcnt(15)
    v_mfma_f32_32x32x16_bf16 v[112:127], v[156:159], v[88:91], 0
    buffer_load_dwordx4 a[80:83], v2, s[4:7], s56 offen offset:1024 sc1
    v_cvt_pknorm_u16_f32 v152, v128, v129
    v_cvt_pknorm_u16_f32 v153, v130, v131
    v_add_u32 v144, s26, v152
    v_add_u32 v145, s26, v153
    v_pk_fmac_f16 v144, s27, v152
    v_pk_fmac_f16 v145, s27, v153
    v_mfma_f32_32x32x16_f16 v[64:79], v[200:203], v[148:151], v[64:79]
    s_mov_b32 s72, 0xc98000
    v_cvt_pknorm_u16_f32 v152, v132, v133
    v_cvt_pknorm_u16_f32 v153, v134, v135
    v_add_u32 v146, s26, v152
    v_add_u32 v147, s26, v153
    v_pk_fmac_f16 v146, s27, v152
    v_pk_fmac_f16 v147, s27, v153
    v_mfma_f32_32x32x16_bf16 v[112:127], v[160:163], v[92:95], v[112:127]
    buffer_load_dwordx4 v[176:179], v1, s[4:7], s43 offen offset:1024 sc1
    v_cvt_pknorm_u16_f32 v152, v136, v137
    v_cvt_pknorm_u16_f32 v153, v138, v139
    v_add_u32 v148, s26, v152
    v_add_u32 v149, s26, v153
    v_pk_fmac_f16 v148, s27, v152
    v_pk_fmac_f16 v149, s27, v153
    v_mfma_f32_32x32x16_f16 v[16:31], v[196:199], v[144:147], v[16:31]
    v_cvt_pknorm_u16_f32 v152, v140, v141
    v_cvt_pknorm_u16_f32 v153, v142, v143
    v_add_u32 v150, s26, v152
    v_add_u32 v151, s26, v153
    v_pk_fmac_f16 v150, s27, v152
    v_pk_fmac_f16 v151, s27, v153
    v_mfma_f32_32x32x16_bf16 v[128:143], v[156:159], v[96:99], 0
    v_max3_u32 v3, v3, v156, v160
    buffer_load_dwordx4 a[84:87], v2, s[4:7], s56 offen offset:2048 sc1
    v_cvt_pknorm_u16_f32 v152, v112, v113
    v_cvt_pknorm_u16_f32 v153, v114, v115
    v_add_u32 v144, s26, v152
    v_add_u32 v145, s26, v153
    v_pk_fmac_f16 v144, s27, v152
    v_pk_fmac_f16 v145, s27, v153
    v_mfma_f32_32x32x16_f16 v[16:31], v[200:203], v[148:151], v[16:31]
    v_cvt_pknorm_u16_f32 v152, v116, v117
    v_cvt_pknorm_u16_f32 v153, v118, v119
    v_add_u32 v146, s26, v152
    v_add_u32 v147, s26, v153
    v_pk_fmac_f16 v146, s27, v152
    v_pk_fmac_f16 v147, s27, v153
    v_mfma_f32_32x32x16_bf16 v[128:143], v[160:163], v[100:103], v[128:143]
    buffer_load_dwordx4 v[196:199], v1, s[4:7], s43 offen offset:2048 sc1
    v_cvt_pknorm_u16_f32 v152, v120, v121
    v_cvt_pknorm_u16_f32 v153, v122, v123
    v_add_u32 v148, s26, v152
    v_add_u32 v149, s26, v153
    v_pk_fmac_f16 v148, s27, v152
    v_pk_fmac_f16 v149, s27, v153
    s_waitcnt vmcnt(15)
    v_mfma_f32_32x32x16_f16 v[32:47], v[180:183], v[144:147], v[32:47]
    v_cvt_pknorm_u16_f32 v152, v124, v125
    v_cvt_pknorm_u16_f32 v153, v126, v127
    v_add_u32 v150, s26, v152
    v_add_u32 v151, s26, v153
    v_pk_fmac_f16 v150, s27, v152
    v_pk_fmac_f16 v151, s27, v153
    v_mfma_f32_32x32x16_bf16 v[112:127], v[156:159], v[104:107], 0
    buffer_load_dwordx4 a[88:91], v2, s[4:7], s56 offen offset:3072 sc1
    v_cvt_pknorm_u16_f32 v152, v128, v129
    v_cvt_pknorm_u16_f32 v153, v130, v131
    v_add_u32 v144, s26, v152
    v_add_u32 v145, s26, v153
    v_pk_fmac_f16 v144, s27, v152
    v_pk_fmac_f16 v145, s27, v153
    v_mfma_f32_32x32x16_f16 v[32:47], v[184:187], v[148:151], v[32:47]
    v_cvt_pknorm_u16_f32 v152, v132, v133
    v_cvt_pknorm_u16_f32 v153, v134, v135
    v_add_u32 v146, s26, v152
    v_add_u32 v147, s26, v153
    v_pk_fmac_f16 v146, s27, v152
    v_pk_fmac_f16 v147, s27, v153
    v_mfma_f32_32x32x16_bf16 v[112:127], v[160:163], v[108:111], v[112:127]
    buffer_load_dwordx4 v[200:203], v1, s[4:7], s43 offen offset:3072 sc1
    v_cvt_pknorm_u16_f32 v152, v136, v137
    v_cvt_pknorm_u16_f32 v153, v138, v139
    v_add_u32 v148, s26, v152
    v_add_u32 v149, s26, v153
    v_pk_fmac_f16 v148, s27, v152
    v_pk_fmac_f16 v149, s27, v153
    v_mfma_f32_32x32x16_f16 v[48:63], v[180:183], v[144:147], v[48:63]
    v_cvt_pknorm_u16_f32 v152, v140, v141
    v_cvt_pknorm_u16_f32 v153, v142, v143
    v_add_u32 v150, s26, v152
    v_add_u32 v151, s26, v153
    v_pk_fmac_f16 v150, s27, v152
    v_pk_fmac_f16 v151, s27, v153
    v_mfma_f32_32x32x16_bf16 v[128:143], v[156:159], v[80:83], 0
    buffer_load_dwordx4 a[92:95], v2, s[4:7], s57 offen offset:0 sc1
    v_cvt_pknorm_u16_f32 v152, v112, v113
    v_cvt_pknorm_u16_f32 v153, v114, v115
    v_add_u32 v144, s26, v152
    v_add_u32 v145, s26, v153
    v_pk_fmac_f16 v144, s27, v152
    v_pk_fmac_f16 v145, s27, v153
    v_mfma_f32_32x32x16_f16 v[48:63], v[184:187], v[148:151], v[48:63]
    v_cvt_pknorm_u16_f32 v152, v116, v117
    v_cvt_pknorm_u16_f32 v153, v118, v119
    v_add_u32 v146, s26, v152
    v_add_u32 v147, s26, v153
    v_pk_fmac_f16 v146, s27, v152
    v_pk_fmac_f16 v147, s27, v153
    v_mfma_f32_32x32x16_bf16 v[128:143], v[160:163], v[84:87], v[128:143]
    buffer_load_dwordx4 v[156:159], v1, s[4:7], s44 offen offset:0 sc1
    v_cvt_pknorm_u16_f32 v152, v120, v121
    v_cvt_pknorm_u16_f32 v153, v122, v123
    v_add_u32 v148, s26, v152
    v_add_u32 v149, s26, v153
    v_pk_fmac_f16 v148, s27, v152
    v_pk_fmac_f16 v149, s27, v153
    v_mfma_f32_32x32x16_f16 v[64:79], v[180:183], v[144:147], v[64:79]
    v_cvt_pknorm_u16_f32 v152, v124, v125
    v_cvt_pknorm_u16_f32 v153, v126, v127
    v_add_u32 v150, s26, v152
    v_add_u32 v151, s26, v153
    v_pk_fmac_f16 v150, s27, v152
    v_pk_fmac_f16 v151, s27, v153
    s_waitcnt vmcnt(14)
    v_mfma_f32_32x32x16_bf16 v[112:127], v[164:167], v[88:91], 0
    buffer_load_dwordx4 a[96:99], v2, s[4:7], s57 offen offset:1024 sc1
    v_cvt_pknorm_u16_f32 v152, v128, v129
    v_cvt_pknorm_u16_f32 v153, v130, v131
    v_add_u32 v144, s26, v152
    v_add_u32 v145, s26, v153
    v_pk_fmac_f16 v144, s27, v152
    v_pk_fmac_f16 v145, s27, v153
    v_mfma_f32_32x32x16_f16 v[64:79], v[184:187], v[148:151], v[64:79]
    v_cvt_pknorm_u16_f32 v152, v132, v133
    v_cvt_pknorm_u16_f32 v153, v134, v135
    v_add_u32 v146, s26, v152
    v_add_u32 v147, s26, v153
    v_pk_fmac_f16 v146, s27, v152
    v_pk_fmac_f16 v147, s27, v153
    v_mfma_f32_32x32x16_bf16 v[112:127], v[168:171], v[92:95], v[112:127]
    buffer_load_dwordx4 v[160:163], v1, s[4:7], s44 offen offset:1024 sc1
    v_cvt_pknorm_u16_f32 v152, v136, v137
    v_cvt_pknorm_u16_f32 v153, v138, v139
    v_add_u32 v148, s26, v152
    v_add_u32 v149, s26, v153
    v_pk_fmac_f16 v148, s27, v152
    v_pk_fmac_f16 v149, s27, v153
    v_mfma_f32_32x32x16_f16 v[16:31], v[180:183], v[144:147], v[16:31]
    v_cvt_pknorm_u16_f32 v152, v140, v141
    v_cvt_pknorm_u16_f32 v153, v142, v143
    v_add_u32 v150, s26, v152
    v_add_u32 v151, s26, v153
    v_pk_fmac_f16 v150, s27, v152
    v_pk_fmac_f16 v151, s27, v153
    v_mfma_f32_32x32x16_bf16 v[128:143], v[164:167], v[96:99], 0
    v_max3_u32 v3, v3, v164, v168
    buffer_load_dwordx4 a[100:103], v2, s[4:7], s57 offen offset:2048 sc1
    v_cvt_pknorm_u16_f32 v152, v112, v113
    v_cvt_pknorm_u16_f32 v153, v114, v115
    v_add_u32 v144, s26, v152
    v_add_u32 v145, s26, v153
    v_pk_fmac_f16 v144, s27, v152
    v_pk_fmac_f16 v145, s27, v153
    v_mfma_f32_32x32x16_f16 v[16:31], v[184:187], v[148:151], v[16:31]
    v_cvt_pknorm_u16_f32 v152, v116, v117
    v_cvt_pknorm_u16_f32 v153, v118, v119
    v_add_u32 v146, s26, v152
    v_add_u32 v147, s26, v153
    v_pk_fmac_f16 v146, s27, v152
    v_pk_fmac_f16 v147, s27, v153
    v_mfma_f32_32x32x16_bf16 v[128:143], v[168:171], v[100:103], v[128:143]
    buffer_load_dwordx4 v[180:183], v1, s[4:7], s44 offen offset:2048 sc1
    v_cvt_pknorm_u16_f32 v152, v120, v121
    v_cvt_pknorm_u16_f32 v153, v122, v123
    v_add_u32 v148, s26, v152
    v_add_u32 v149, s26, v153
    v_pk_fmac_f16 v148, s27, v152
    v_pk_fmac_f16 v149, s27, v153
    s_waitcnt vmcnt(14)
    v_mfma_f32_32x32x16_f16 v[32:47], v[188:191], v[144:147], v[32:47]
    v_cvt_pknorm_u16_f32 v152, v124, v125
    v_cvt_pknorm_u16_f32 v153, v126, v127
    v_add_u32 v150, s26, v152
    v_add_u32 v151, s26, v153
    v_pk_fmac_f16 v150, s27, v152
    v_pk_fmac_f16 v151, s27, v153
    v_mfma_f32_32x32x16_bf16 v[112:127], v[164:167], v[104:107], 0
    buffer_load_dwordx4 a[104:107], v2, s[4:7], s57 offen offset:3072 sc1
    v_cvt_pknorm_u16_f32 v152, v128, v129
    v_cvt_pknorm_u16_f32 v153, v130, v131
    v_add_u32 v144, s26, v152
    v_add_u32 v145, s26, v153
    v_pk_fmac_f16 v144, s27, v152
    v_pk_fmac_f16 v145, s27, v153
    v_mfma_f32_32x32x16_f16 v[32:47], v[192:195], v[148:151], v[32:47]
    v_cvt_pknorm_u16_f32 v152, v132, v133
    v_cvt_pknorm_u16_f32 v153, v134, v135
    v_add_u32 v146, s26, v152
    v_add_u32 v147, s26, v153
    v_pk_fmac_f16 v146, s27, v152
    v_pk_fmac_f16 v147, s27, v153
    v_mfma_f32_32x32x16_bf16 v[112:127], v[168:171], v[108:111], v[112:127]
    buffer_load_dwordx4 v[184:187], v1, s[4:7], s44 offen offset:3072 sc1
    v_cvt_pknorm_u16_f32 v152, v136, v137
    v_cvt_pknorm_u16_f32 v153, v138, v139
    v_add_u32 v148, s26, v152
    v_add_u32 v149, s26, v153
    v_pk_fmac_f16 v148, s27, v152
    v_pk_fmac_f16 v149, s27, v153
    v_mfma_f32_32x32x16_f16 v[48:63], v[188:191], v[144:147], v[48:63]
    v_cvt_pknorm_u16_f32 v152, v140, v141
    v_cvt_pknorm_u16_f32 v153, v142, v143
    v_add_u32 v150, s26, v152
    v_add_u32 v151, s26, v153
    v_pk_fmac_f16 v150, s27, v152
    v_pk_fmac_f16 v151, s27, v153
    v_mfma_f32_32x32x16_bf16 v[128:143], v[164:167], v[80:83], 0
    buffer_load_dwordx4 a[108:111], v2, s[4:7], s58 offen offset:0 sc1
    v_cvt_pknorm_u16_f32 v152, v112, v113
    v_cvt_pknorm_u16_f32 v153, v114, v115
    v_add_u32 v144, s26, v152
    v_add_u32 v145, s26, v153
    v_pk_fmac_f16 v144, s27, v152
    v_pk_fmac_f16 v145, s27, v153
    v_mfma_f32_32x32x16_f16 v[48:63], v[192:195], v[148:151], v[48:63]
    v_cvt_pknorm_u16_f32 v152, v116, v117
    v_cvt_pknorm_u16_f32 v153, v118, v119
    v_add_u32 v146, s26, v152
    v_add_u32 v147, s26, v153
    v_pk_fmac_f16 v146, s27, v152
    v_pk_fmac_f16 v147, s27, v153
    v_mfma_f32_32x32x16_bf16 v[128:143], v[168:171], v[84:87], v[128:143]
    buffer_load_dwordx4 v[164:167], v1, s[4:7], s45 offen offset:0 sc1
    v_cvt_pknorm_u16_f32 v152, v120, v121
    v_cvt_pknorm_u16_f32 v153, v122, v123
    v_add_u32 v148, s26, v152
    v_add_u32 v149, s26, v153
    v_pk_fmac_f16 v148, s27, v152
    v_pk_fmac_f16 v149, s27, v153
    v_mfma_f32_32x32x16_f16 v[64:79], v[188:191], v[144:147], v[64:79]
    v_cvt_pknorm_u16_f32 v152, v124, v125
    v_cvt_pknorm_u16_f32 v153, v126, v127
    v_add_u32 v150, s26, v152
    v_add_u32 v151, s26, v153
    v_pk_fmac_f16 v150, s27, v152
    v_pk_fmac_f16 v151, s27, v153
    s_waitcnt vmcnt(14)
    v_mfma_f32_32x32x16_bf16 v[112:127], v[172:175], v[88:91], 0
    buffer_load_dwordx4 a[112:115], v2, s[4:7], s58 offen offset:1024 sc1
    v_cvt_pknorm_u16_f32 v152, v128, v129
    v_cvt_pknorm_u16_f32 v153, v130, v131
    v_add_u32 v144, s26, v152
    v_add_u32 v145, s26, v153
    v_pk_fmac_f16 v144, s27, v152
    v_pk_fmac_f16 v145, s27, v153
    v_mfma_f32_32x32x16_f16 v[64:79], v[192:195], v[148:151], v[64:79]
    v_cvt_pknorm_u16_f32 v152, v132, v133
    v_cvt_pknorm_u16_f32 v153, v134, v135
    v_add_u32 v146, s26, v152
    v_add_u32 v147, s26, v153
    v_pk_fmac_f16 v146, s27, v152
    v_pk_fmac_f16 v147, s27, v153
    v_mfma_f32_32x32x16_bf16 v[112:127], v[176:179], v[92:95], v[112:127]
    buffer_load_dwordx4 v[168:171], v1, s[4:7], s45 offen offset:1024 sc1
    v_cvt_pknorm_u16_f32 v152, v136, v137
    v_cvt_pknorm_u16_f32 v153, v138, v139
    v_add_u32 v148, s26, v152
    v_add_u32 v149, s26, v153
    v_pk_fmac_f16 v148, s27, v152
    v_pk_fmac_f16 v149, s27, v153
    v_mfma_f32_32x32x16_f16 v[16:31], v[188:191], v[144:147], v[16:31]
    v_cvt_pknorm_u16_f32 v152, v140, v141
    v_cvt_pknorm_u16_f32 v153, v142, v143
    v_add_u32 v150, s26, v152
    v_add_u32 v151, s26, v153
    v_pk_fmac_f16 v150, s27, v152
    v_pk_fmac_f16 v151, s27, v153
    v_mfma_f32_32x32x16_bf16 v[128:143], v[172:175], v[96:99], 0
    v_max3_u32 v3, v3, v172, v176
    buffer_load_dwordx4 a[116:119], v2, s[4:7], s58 offen offset:2048 sc1
    v_cvt_pknorm_u16_f32 v152, v112, v113
    v_cvt_pknorm_u16_f32 v153, v114, v115
    v_add_u32 v144, s26, v152
    v_add_u32 v145, s26, v153
    v_pk_fmac_f16 v144, s27, v152
    v_pk_fmac_f16 v145, s27, v153
    v_mfma_f32_32x32x16_f16 v[16:31], v[192:195], v[148:151], v[16:31]
    global_load_dwordx2 v[14:15], v6, s[14:15] sc1
    v_cvt_pknorm_u16_f32 v152, v116, v117
    v_cvt_pknorm_u16_f32 v153, v118, v119
    v_add_u32 v146, s26, v152
    v_add_u32 v147, s26, v153
    v_pk_fmac_f16 v146, s27, v152
    v_pk_fmac_f16 v147, s27, v153
    v_mfma_f32_32x32x16_bf16 v[128:143], v[176:179], v[100:103], v[128:143]
    buffer_load_dwordx4 v[188:191], v1, s[4:7], s45 offen offset:2048 sc1
    v_cvt_pknorm_u16_f32 v152, v120, v121
    v_cvt_pknorm_u16_f32 v153, v122, v123
    v_add_u32 v148, s26, v152
    v_add_u32 v149, s26, v153
    v_pk_fmac_f16 v148, s27, v152
    v_pk_fmac_f16 v149, s27, v153
    s_waitcnt vmcnt(15)
    v_mfma_f32_32x32x16_f16 v[32:47], v[196:199], v[144:147], v[32:47]
    v_cvt_pknorm_u16_f32 v152, v124, v125
    v_cvt_pknorm_u16_f32 v153, v126, v127
    v_add_u32 v150, s26, v152
    v_add_u32 v151, s26, v153
    v_pk_fmac_f16 v150, s27, v152
    v_pk_fmac_f16 v151, s27, v153
    v_mfma_f32_32x32x16_bf16 v[112:127], v[172:175], v[104:107], 0
    buffer_load_dwordx4 a[120:123], v2, s[4:7], s58 offen offset:3072 sc1
    v_cvt_pknorm_u16_f32 v152, v128, v129
    v_cvt_pknorm_u16_f32 v153, v130, v131
    v_add_u32 v144, s26, v152
    v_add_u32 v145, s26, v153
    v_pk_fmac_f16 v144, s27, v152
    v_pk_fmac_f16 v145, s27, v153
    v_mfma_f32_32x32x16_f16 v[32:47], v[200:203], v[148:151], v[32:47]
    v_cvt_pknorm_u16_f32 v152, v132, v133
    v_cvt_pknorm_u16_f32 v153, v134, v135
    v_add_u32 v146, s26, v152
    v_add_u32 v147, s26, v153
    v_pk_fmac_f16 v146, s27, v152
    v_pk_fmac_f16 v147, s27, v153
    v_mfma_f32_32x32x16_bf16 v[112:127], v[176:179], v[108:111], v[112:127]
    buffer_load_dwordx4 v[192:195], v1, s[4:7], s45 offen offset:3072 sc1
    v_cvt_pknorm_u16_f32 v152, v136, v137
    v_cvt_pknorm_u16_f32 v153, v138, v139
    v_add_u32 v148, s26, v152
    v_add_u32 v149, s26, v153
    v_pk_fmac_f16 v148, s27, v152
    v_pk_fmac_f16 v149, s27, v153
    v_mfma_f32_32x32x16_f16 v[48:63], v[196:199], v[144:147], v[48:63]
    v_cvt_pknorm_u16_f32 v152, v140, v141
    v_cvt_pknorm_u16_f32 v153, v142, v143
    v_add_u32 v150, s26, v152
    v_add_u32 v151, s26, v153
    v_pk_fmac_f16 v150, s27, v152
    v_pk_fmac_f16 v151, s27, v153
    v_mfma_f32_32x32x16_bf16 v[128:143], v[172:175], v[80:83], 0
    buffer_load_dwordx4 a[124:127], v2, s[4:7], s59 offen offset:0 sc1
    v_cvt_pknorm_u16_f32 v152, v112, v113
    v_cvt_pknorm_u16_f32 v153, v114, v115
    v_add_u32 v144, s26, v152
    v_add_u32 v145, s26, v153
    v_pk_fmac_f16 v144, s27, v152
    v_pk_fmac_f16 v145, s27, v153
    v_mfma_f32_32x32x16_f16 v[48:63], v[200:203], v[148:151], v[48:63]
    v_cvt_pknorm_u16_f32 v152, v116, v117
    v_cvt_pknorm_u16_f32 v153, v118, v119
    v_add_u32 v146, s26, v152
    v_add_u32 v147, s26, v153
    v_pk_fmac_f16 v146, s27, v152
    v_pk_fmac_f16 v147, s27, v153
    v_mfma_f32_32x32x16_bf16 v[128:143], v[176:179], v[84:87], v[128:143]
    buffer_load_dwordx4 v[172:175], v1, s[4:7], s46 offen offset:0 sc1
    v_cvt_pknorm_u16_f32 v152, v120, v121
    v_cvt_pknorm_u16_f32 v153, v122, v123
    v_add_u32 v148, s26, v152
    v_add_u32 v149, s26, v153
    v_pk_fmac_f16 v148, s27, v152
    v_pk_fmac_f16 v149, s27, v153
    v_mfma_f32_32x32x16_f16 v[64:79], v[196:199], v[144:147], v[64:79]
    v_cvt_pknorm_u16_f32 v152, v124, v125
    v_cvt_pknorm_u16_f32 v153, v126, v127
    v_add_u32 v150, s26, v152
    v_add_u32 v151, s26, v153
    v_pk_fmac_f16 v150, s27, v152
    v_pk_fmac_f16 v151, s27, v153
    s_waitcnt vmcnt(15)
    v_mfma_f32_32x32x16_bf16 v[112:127], v[156:159], v[88:91], 0
    buffer_load_dwordx4 a[128:131], v2, s[4:7], s59 offen offset:1024 sc1
    v_cvt_pknorm_u16_f32 v152, v128, v129
    v_cvt_pknorm_u16_f32 v153, v130, v131
    v_add_u32 v144, s26, v152
    v_add_u32 v145, s26, v153
    v_pk_fmac_f16 v144, s27, v152
    v_pk_fmac_f16 v145, s27, v153
    v_mfma_f32_32x32x16_f16 v[64:79], v[200:203], v[148:151], v[64:79]
    v_cvt_pknorm_u16_f32 v152, v132, v133
    v_cvt_pknorm_u16_f32 v153, v134, v135
    v_add_u32 v146, s26, v152
    v_add_u32 v147, s26, v153
    v_pk_fmac_f16 v146, s27, v152
    v_pk_fmac_f16 v147, s27, v153
    v_mfma_f32_32x32x16_bf16 v[112:127], v[160:163], v[92:95], v[112:127]
    buffer_load_dwordx4 v[176:179], v1, s[4:7], s46 offen offset:1024 sc1
    v_cvt_pknorm_u16_f32 v152, v136, v137
    v_cvt_pknorm_u16_f32 v153, v138, v139
    v_add_u32 v148, s26, v152
    v_add_u32 v149, s26, v153
    v_pk_fmac_f16 v148, s27, v152
    v_pk_fmac_f16 v149, s27, v153
    v_mfma_f32_32x32x16_f16 v[16:31], v[196:199], v[144:147], v[16:31]
    v_cvt_pknorm_u16_f32 v152, v140, v141
    v_cvt_pknorm_u16_f32 v153, v142, v143
    v_add_u32 v150, s26, v152
    v_add_u32 v151, s26, v153
    v_pk_fmac_f16 v150, s27, v152
    v_pk_fmac_f16 v151, s27, v153
    v_mfma_f32_32x32x16_bf16 v[128:143], v[156:159], v[96:99], 0
    v_max3_u32 v3, v3, v156, v160
    buffer_load_dwordx4 a[132:135], v2, s[4:7], s59 offen offset:2048 sc1
    v_cvt_pknorm_u16_f32 v152, v112, v113
    v_cvt_pknorm_u16_f32 v153, v114, v115
    v_add_u32 v144, s26, v152
    v_add_u32 v145, s26, v153
    v_pk_fmac_f16 v144, s27, v152
    v_pk_fmac_f16 v145, s27, v153
    v_mfma_f32_32x32x16_f16 v[16:31], v[200:203], v[148:151], v[16:31]
    v_cvt_pknorm_u16_f32 v152, v116, v117
    v_cvt_pknorm_u16_f32 v153, v118, v119
    v_add_u32 v146, s26, v152
    v_add_u32 v147, s26, v153
    v_pk_fmac_f16 v146, s27, v152
    v_pk_fmac_f16 v147, s27, v153
    v_mfma_f32_32x32x16_bf16 v[128:143], v[160:163], v[100:103], v[128:143]
    buffer_load_dwordx4 v[196:199], v1, s[4:7], s46 offen offset:2048 sc1
    v_cvt_pknorm_u16_f32 v152, v120, v121
    v_cvt_pknorm_u16_f32 v153, v122, v123
    v_add_u32 v148, s26, v152
    v_add_u32 v149, s26, v153
    v_pk_fmac_f16 v148, s27, v152
    v_pk_fmac_f16 v149, s27, v153
    s_waitcnt vmcnt(15)
    v_mfma_f32_32x32x16_f16 v[32:47], v[180:183], v[144:147], v[32:47]
    v_cvt_pknorm_u16_f32 v152, v124, v125
    v_cvt_pknorm_u16_f32 v153, v126, v127
    v_add_u32 v150, s26, v152
    v_add_u32 v151, s26, v153
    v_pk_fmac_f16 v150, s27, v152
    v_pk_fmac_f16 v151, s27, v153
    v_mfma_f32_32x32x16_bf16 v[112:127], v[156:159], v[104:107], 0
    buffer_load_dwordx4 a[136:139], v2, s[4:7], s59 offen offset:3072 sc1
    v_cvt_pknorm_u16_f32 v152, v128, v129
    v_cvt_pknorm_u16_f32 v153, v130, v131
    v_add_u32 v144, s26, v152
    v_add_u32 v145, s26, v153
    v_pk_fmac_f16 v144, s27, v152
    v_pk_fmac_f16 v145, s27, v153
    v_mfma_f32_32x32x16_f16 v[32:47], v[184:187], v[148:151], v[32:47]
    v_cvt_pknorm_u16_f32 v152, v132, v133
    v_cvt_pknorm_u16_f32 v153, v134, v135
    v_add_u32 v146, s26, v152
    v_add_u32 v147, s26, v153
    v_pk_fmac_f16 v146, s27, v152
    v_pk_fmac_f16 v147, s27, v153
    v_mfma_f32_32x32x16_bf16 v[112:127], v[160:163], v[108:111], v[112:127]
    buffer_load_dwordx4 v[200:203], v1, s[4:7], s46 offen offset:3072 sc1
    v_cvt_pknorm_u16_f32 v152, v136, v137
    v_cvt_pknorm_u16_f32 v153, v138, v139
    v_add_u32 v148, s26, v152
    v_add_u32 v149, s26, v153
    v_pk_fmac_f16 v148, s27, v152
    v_pk_fmac_f16 v149, s27, v153
    v_mfma_f32_32x32x16_f16 v[48:63], v[180:183], v[144:147], v[48:63]
    v_cvt_pknorm_u16_f32 v152, v140, v141
    v_cvt_pknorm_u16_f32 v153, v142, v143
    v_add_u32 v150, s26, v152
    v_add_u32 v151, s26, v153
    v_pk_fmac_f16 v150, s27, v152
    v_pk_fmac_f16 v151, s27, v153
    v_mfma_f32_32x32x16_bf16 v[128:143], v[156:159], v[80:83], 0
    buffer_load_dwordx4 a[140:143], v2, s[4:7], s60 offen offset:0 sc1
    v_cvt_pknorm_u16_f32 v152, v112, v113
    v_cvt_pknorm_u16_f32 v153, v114, v115
    v_add_u32 v144, s26, v152
    v_add_u32 v145, s26, v153
    v_pk_fmac_f16 v144, s27, v152
    v_pk_fmac_f16 v145, s27, v153
    v_mfma_f32_32x32x16_f16 v[48:63], v[184:187], v[148:151], v[48:63]
    s_waitcnt vmcnt(12)
k2_ffa:
    v_cmpx_le_u64 vcc, s[80:81], v[14:15]
    v_cmpx_ge_u64 vcc, s[82:83], v[14:15]
    s_nop 0
    s_cmp_eq_u64 exec, -1
    s_mov_b64 exec, -1
    s_cbranch_scc0 k2_ffb
k2_ffc:
    v_cvt_pknorm_u16_f32 v152, v116, v117
    v_cvt_pknorm_u16_f32 v153, v118, v119
    v_add_u32 v146, s26, v152
    v_add_u32 v147, s26, v153
    v_pk_fmac_f16 v146, s27, v152
    v_pk_fmac_f16 v147, s27, v153
    v_mfma_f32_32x32x16_bf16 v[128:143], v[160:163], v[84:87], v[128:143]
    buffer_load_dwordx4 v[156:159], v1, s[4:7], s47 offen offset:0 sc1
    v_cvt_pknorm_u16_f32 v152, v120, v121
    v_cvt_pknorm_u16_f32 v153, v122, v123
    v_add_u32 v148, s26, v152
    v_add_u32 v149, s26, v153
    v_pk_fmac_f16 v148, s27, v152
    v_pk_fmac_f16 v149, s27, v153
    v_mfma_f32_32x32x16_f16 v[64:79], v[180:183], v[144:147], v[64:79]
    v_cvt_pknorm_u16_f32 v152, v124, v125
    v_cvt_pknorm_u16_f32 v153, v126, v127
    v_add_u32 v150, s26, v152
    v_add_u32 v151, s26, v153
    v_pk_fmac_f16 v150, s27, v152
    v_pk_fmac_f16 v151, s27, v153
    v_mfma_f32_32x32x16_bf16 v[112:127], v[164:167], v[88:91], 0
    buffer_load_dwordx4 a[144:147], v2, s[4:7], s60 offen offset:1024 sc1
    v_cvt_pknorm_u16_f32 v152, v128, v129
    v_cvt_pknorm_u16_f32 v153, v130, v131
    v_add_u32 v144, s26, v152
    v_add_u32 v145, s26, v153
    v_pk_fmac_f16 v144, s27, v152
    v_pk_fmac_f16 v145, s27, v153
    v_mfma_f32_32x32x16_f16 v[64:79], v[184:187], v[148:151], v[64:79]
    v_cvt_pknorm_u16_f32 v152, v132, v133
    v_cvt_pknorm_u16_f32 v153, v134, v135
    v_add_u32 v146, s26, v152
    v_add_u32 v147, s26, v153
    v_pk_fmac_f16 v146, s27, v152
    v_pk_fmac_f16 v147, s27, v153
    v_mfma_f32_32x32x16_bf16 v[112:127], v[168:171], v[92:95], v[112:127]
    buffer_load_dwordx4 v[160:163], v1, s[4:7], s47 offen offset:1024 sc1
    v_cvt_pknorm_u16_f32 v152, v136, v137
    v_cvt_pknorm_u16_f32 v153, v138, v139
    v_add_u32 v148, s26, v152
    v_add_u32 v149, s26, v153
    v_pk_fmac_f16 v148, s27, v152
    v_pk_fmac_f16 v149, s27, v153
    v_mfma_f32_32x32x16_f16 v[16:31], v[180:183], v[144:147], v[16:31]
    v_cvt_pknorm_u16_f32 v152, v140, v141
    v_cvt_pknorm_u16_f32 v153, v142, v143
    v_add_u32 v150, s26, v152
    v_add_u32 v151, s26, v153
    v_pk_fmac_f16 v150, s27, v152
    v_pk_fmac_f16 v151, s27, v153
    v_mfma_f32_32x32x16_bf16 v[128:143], v[164:167], v[96:99], 0
    buffer_load_dwordx4 v[180:183], v1, s[4:7], s47 offen offset:2048 sc1
    v_max3_u32 v3, v3, v164, v168
    v_cvt_pknorm_u16_f32 v152, v112, v113
    v_cvt_pknorm_u16_f32 v153, v114, v115
    v_add_u32 v144, s26, v152
    v_add_u32 v145, s26, v153
    v_pk_fmac_f16 v144, s27, v152
    v_pk_fmac_f16 v145, s27, v153
    v_mfma_f32_32x32x16_f16 v[16:31], v[184:187], v[148:151], v[16:31]
    v_cvt_pknorm_u16_f32 v152, v116, v117
    v_cvt_pknorm_u16_f32 v153, v118, v119
    v_add_u32 v146, s26, v152
    v_add_u32 v147, s26, v153
    v_pk_fmac_f16 v146, s27, v152
    v_pk_fmac_f16 v147, s27, v153
    v_mfma_f32_32x32x16_bf16 v[128:143], v[168:171], v[100:103], v[128:143]
    buffer_load_dwordx4 v[184:187], v1, s[4:7], s47 offen offset:3072 sc1
    v_cvt_pknorm_u16_f32 v152, v120, v121
    v_cvt_pknorm_u16_f32 v153, v122, v123
    v_add_u32 v148, s26, v152
    v_add_u32 v149, s26, v153
    v_pk_fmac_f16 v148, s27, v152
    v_pk_fmac_f16 v149, s27, v153
    s_waitcnt vmcnt(14)
    v_mfma_f32_32x32x16_f16 v[32:47], v[188:191], v[144:147], v[32:47]
    v_cvt_pknorm_u16_f32 v152, v124, v125
    v_cvt_pknorm_u16_f32 v153, v126, v127
    v_add_u32 v150, s26, v152
    v_add_u32 v151, s26, v153
    v_pk_fmac_f16 v150, s27, v152
    v_pk_fmac_f16 v151, s27, v153
    v_mfma_f32_32x32x16_bf16 v[112:127], v[164:167], v[104:107], 0
    buffer_load_dwordx4 a[148:151], v2, s[4:7], s60 offen offset:2048 sc1
    v_cvt_pknorm_u16_f32 v152, v128, v129
    v_cvt_pknorm_u16_f32 v153, v130, v131
    v_add_u32 v144, s26, v152
    v_add_u32 v145, s26, v153
    v_pk_fmac_f16 v144, s27, v152
    v_pk_fmac_f16 v145, s27, v153
    v_mfma_f32_32x32x16_f16 v[32:47], v[192:195], v[148:151], v[32:47]
    v_cvt_pknorm_u16_f32 v152, v132, v133
    v_cvt_pknorm_u16_f32 v153, v134, v135
    v_add_u32 v146, s26, v152
    v_add_u32 v147, s26, v153
    v_pk_fmac_f16 v146, s27, v152
    v_pk_fmac_f16 v147, s27, v153
    v_mfma_f32_32x32x16_bf16 v[112:127], v[168:171], v[108:111], v[112:127]
    buffer_load_dwordx4 a[152:155], v2, s[4:7], s60 offen offset:3072 sc1
    v_cvt_pknorm_u16_f32 v152, v136, v137
    v_cvt_pknorm_u16_f32 v153, v138, v139
    v_add_u32 v148, s26, v152
    v_add_u32 v149, s26, v153
    v_pk_fmac_f16 v148, s27, v152
    v_pk_fmac_f16 v149, s27, v153
    v_mfma_f32_32x32x16_f16 v[48:63], v[188:191], v[144:147], v[48:63]
    v_cvt_pknorm_u16_f32 v152, v140, v141
    v_cvt_pknorm_u16_f32 v153, v142, v143
    v_add_u32 v150, s26, v152
    v_add_u32 v151, s26, v153
    v_pk_fmac_f16 v150, s27, v152
    v_pk_fmac_f16 v151, s27, v153
    v_mfma_f32_32x32x16_bf16 v[128:143], v[164:167], v[80:83], 0
    buffer_load_dwordx4 a[156:159], v2, s[4:7], s61 offen offset:0 sc1
    v_cvt_pknorm_u16_f32 v152, v112, v113
    v_cvt_pknorm_u16_f32 v153, v114, v115
    v_add_u32 v144, s26, v152
    v_add_u32 v145, s26, v153
    v_pk_fmac_f16 v144, s27, v152
    v_pk_fmac_f16 v145, s27, v153
    v_mfma_f32_32x32x16_f16 v[48:63], v[192:195], v[148:151], v[48:63]
    v_cvt_pknorm_u16_f32 v152, v116, v117
    v_cvt_pknorm_u16_f32 v153, v118, v119
    v_add_u32 v146, s26, v152
    v_add_u32 v147, s26, v153
    v_pk_fmac_f16 v146, s27, v152
    v_pk_fmac_f16 v147, s27, v153
    v_mfma_f32_32x32x16_bf16 v[128:143], v[168:171], v[84:87], v[128:143]
    buffer_load_dwordx4 a[160:163], v2, s[4:7], s61 offen offset:1024 sc1
    v_cvt_pknorm_u16_f32 v152, v120, v121
    v_cvt_pknorm_u16_f32 v153, v122, v123
    v_add_u32 v148, s26, v152
    v_add_u32 v149, s26, v153
    v_pk_fmac_f16 v148, s27, v152
    v_pk_fmac_f16 v149, s27, v153
    v_mfma_f32_32x32x16_f16 v[64:79], v[188:191], v[144:147], v[64:79]
    v_cvt_pknorm_u16_f32 v152, v124, v125
    v_cvt_pknorm_u16_f32 v153, v126, v127
    v_add_u32 v150, s26, v152
    v_add_u32 v151, s26, v153
    v_pk_fmac_f16 v150, s27, v152
    v_pk_fmac_f16 v151, s27, v153
    s_waitcnt vmcnt(14)
    v_mfma_f32_32x32x16_bf16 v[112:127], v[172:175], v[88:91], 0
    buffer_load_dwordx4 a[164:167], v2, s[4:7], s61 offen offset:2048 sc1
    v_cvt_pknorm_u16_f32 v152, v128, v129
    v_cvt_pknorm_u16_f32 v153, v130, v131
    v_add_u32 v144, s26, v152
    v_add_u32 v145, s26, v153
    v_pk_fmac_f16 v144, s27, v152
    v_pk_fmac_f16 v145, s27, v153
    v_mfma_f32_32x32x16_f16 v[64:79], v[192:195], v[148:151], v[64:79]
    v_cvt_pknorm_u16_f32 v152, v132, v133
    v_cvt_pknorm_u16_f32 v153, v134, v135
    v_add_u32 v146, s26, v152
    v_add_u32 v147, s26, v153
    v_pk_fmac_f16 v146, s27, v152
    v_pk_fmac_f16 v147, s27, v153
    v_mfma_f32_32x32x16_bf16 v[112:127], v[176:179], v[92:95], v[112:127]
    buffer_load_dwordx4 a[168:171], v2, s[4:7], s61 offen offset:3072 sc1
    v_cvt_pknorm_u16_f32 v152, v136, v137
    v_cvt_pknorm_u16_f32 v153, v138, v139
    v_add_u32 v148, s26, v152
    v_add_u32 v149, s26, v153
    v_pk_fmac_f16 v148, s27, v152
    v_pk_fmac_f16 v149, s27, v153
    v_mfma_f32_32x32x16_f16 v[16:31], v[188:191], v[144:147], v[16:31]
    v_cvt_pknorm_u16_f32 v152, v140, v141
    v_cvt_pknorm_u16_f32 v153, v142, v143
    v_add_u32 v150, s26, v152
    v_add_u32 v151, s26, v153
    v_pk_fmac_f16 v150, s27, v152
    v_pk_fmac_f16 v151, s27, v153
    s_waitcnt vmcnt(8)
    v_mfma_f32_32x32x16_bf16 v[128:143], v[156:159], v[88:91], 0
    v_max3_u32 v3, v3, v172, v176
    buffer_load_dwordx4 a[172:175], v2, s[4:7], s62 offen offset:0 sc1
    v_cvt_pknorm_u16_f32 v152, v112, v113
    v_cvt_pknorm_u16_f32 v153, v114, v115
    v_add_u32 v144, s26, v152
    v_add_u32 v145, s26, v153
    v_pk_fmac_f16 v144, s27, v152
    v_pk_fmac_f16 v145, s27, v153
    v_mfma_f32_32x32x16_f16 v[16:31], v[192:195], v[148:151], v[16:31]
    v_cvt_pknorm_u16_f32 v152, v116, v117
    v_cvt_pknorm_u16_f32 v153, v118, v119
    v_add_u32 v146, s26, v152
    v_add_u32 v147, s26, v153
    v_pk_fmac_f16 v146, s27, v152
    v_pk_fmac_f16 v147, s27, v153
    v_mfma_f32_32x32x16_bf16 v[128:143], v[160:163], v[92:95], v[128:143]
    buffer_load_dwordx4 a[176:179], v2, s[4:7], s62 offen offset:1024 sc1
    v_cvt_pknorm_u16_f32 v152, v120, v121
    v_cvt_pknorm_u16_f32 v153, v122, v123
    v_add_u32 v148, s26, v152
    v_add_u32 v149, s26, v153
    v_pk_fmac_f16 v148, s27, v152
    v_pk_fmac_f16 v149, s27, v153
    v_mfma_f32_32x32x16_f16 v[32:47], v[196:199], v[144:147], v[32:47]
    v_cvt_pknorm_u16_f32 v152, v124, v125
    v_cvt_pknorm_u16_f32 v153, v126, v127
    v_add_u32 v150, s26, v152
    v_add_u32 v151, s26, v153
    v_pk_fmac_f16 v150, s27, v152
    v_pk_fmac_f16 v151, s27, v153
    v_mfma_f32_32x32x16_bf16 v[112:127], v[172:175], v[96:99], 0
    v_max3_u32 v3, v3, v156, v160
    buffer_load_dwordx4 a[180:183], v2, s[4:7], s62 offen offset:2048 sc1
    v_cvt_pknorm_u16_f32 v152, v128, v129
    v_cvt_pknorm_u16_f32 v153, v130, v131
    v_add_u32 v144, s26, v152
    v_add_u32 v145, s26, v153
    v_pk_fmac_f16 v144, s27, v152
    v_pk_fmac_f16 v145, s27, v153
    v_mfma_f32_32x32x16_f16 v[32:47], v[200:203], v[148:151], v[32:47]
    v_cvt_pknorm_u16_f32 v152, v132, v133
    v_cvt_pknorm_u16_f32 v153, v134, v135
    v_add_u32 v146, s26, v152
    v_add_u32 v147, s26, v153
    v_pk_fmac_f16 v146, s27, v152
    v_pk_fmac_f16 v147, s27, v153
    v_mfma_f32_32x32x16_bf16 v[112:127], v[176:179], v[100:103], v[112:127]
    buffer_load_dwordx4 a[184:187], v2, s[4:7], s62 offen offset:3072 sc1
    v_cvt_pknorm_u16_f32 v152, v136, v137
    v_cvt_pknorm_u16_f32 v153, v138, v139
    v_add_u32 v148, s26, v152
    v_add_u32 v149, s26, v153
    v_pk_fmac_f16 v148, s27, v152
    v_pk_fmac_f16 v149, s27, v153
    s_waitcnt vmcnt(10)
    v_mfma_f32_32x32x16_f16 v[32:47], v[180:183], v[144:147], v[32:47]
    v_cvt_pknorm_u16_f32 v152, v140, v141
    v_cvt_pknorm_u16_f32 v153, v142, v143
    v_add_u32 v150, s26, v152
    v_add_u32 v151, s26, v153
    v_pk_fmac_f16 v150, s27, v152
    v_pk_fmac_f16 v151, s27, v153
    v_mfma_f32_32x32x16_bf16 v[128:143], v[156:159], v[96:99], 0
    buffer_load_dwordx4 a[188:191], v2, s[4:7], s63 offen offset:0 sc1
    v_cvt_pknorm_u16_f32 v152, v112, v113
    v_cvt_pknorm_u16_f32 v153, v114, v115
    v_add_u32 v144, s26, v152
    v_add_u32 v145, s26, v153
    v_pk_fmac_f16 v144, s27, v152
    v_pk_fmac_f16 v145, s27, v153
    v_mfma_f32_32x32x16_f16 v[32:47], v[184:187], v[148:151], v[32:47]
    v_cvt_pknorm_u16_f32 v152, v116, v117
    v_cvt_pknorm_u16_f32 v153, v118, v119
    v_add_u32 v146, s26, v152
    v_add_u32 v147, s26, v153
    v_pk_fmac_f16 v146, s27, v152
    v_pk_fmac_f16 v147, s27, v153
    v_mfma_f32_32x32x16_bf16 v[128:143], v[160:163], v[100:103], v[128:143]
    buffer_load_dwordx4 a[192:195], v2, s[4:7], s63 offen offset:1024 sc1
    v_cvt_pknorm_u16_f32 v152, v120, v121
    v_cvt_pknorm_u16_f32 v153, v122, v123
    v_add_u32 v148, s26, v152
    v_add_u32 v149, s26, v153
    v_pk_fmac_f16 v148, s27, v152
    v_pk_fmac_f16 v149, s27, v153
    v_mfma_f32_32x32x16_f16 v[48:63], v[196:199], v[144:147], v[48:63]
    ds_write_b128 v8, v[32:35] offset:0
    v_cvt_pknorm_u16_f32 v152, v124, v125
    v_cvt_pknorm_u16_f32 v153, v126, v127
    v_add_u32 v150, s26, v152
    v_add_u32 v151, s26, v153
    v_pk_fmac_f16 v150, s27, v152
    v_pk_fmac_f16 v151, s27, v153
    v_mfma_f32_32x32x16_bf16 v[112:127], v[172:175], v[104:107], 0
    global_load_dwordx4 v[96:99], v7, s[16:17]
    ds_write_b128 v8, v[36:39] offset:1024
    v_cvt_pknorm_u16_f32 v152, v128, v129
    v_cvt_pknorm_u16_f32 v153, v130, v131
    v_add_u32 v144, s26, v152
    v_add_u32 v145, s26, v153
    v_pk_fmac_f16 v144, s27, v152
    v_pk_fmac_f16 v145, s27, v153
    v_mfma_f32_32x32x16_f16 v[48:63], v[200:203], v[148:151], v[48:63]
    ds_write_b128 v8, v[40:43] offset:2048
    v_cvt_pknorm_u16_f32 v152, v132, v133
    v_cvt_pknorm_u16_f32 v153, v134, v135
    v_add_u32 v146, s26, v152
    v_add_u32 v147, s26, v153
    v_pk_fmac_f16 v146, s27, v152
    v_pk_fmac_f16 v147, s27, v153
    v_mfma_f32_32x32x16_bf16 v[112:127], v[176:179], v[108:111], v[112:127]
    global_load_dwordx3 v[100:102], v7, s[16:17] offset:16
    ds_write_b128 v8, v[44:47] offset:3072
    v_cvt_pknorm_u16_f32 v152, v136, v137
    v_cvt_pknorm_u16_f32 v153, v138, v139
    v_add_u32 v148, s26, v152
    v_add_u32 v149, s26, v153
    v_pk_fmac_f16 v148, s27, v152
    v_pk_fmac_f16 v149, s27, v153
    v_mfma_f32_32x32x16_f16 v[48:63], v[180:183], v[144:147], v[48:63]
    v_cvt_pknorm_u16_f32 v152, v140, v141
    v_cvt_pknorm_u16_f32 v153, v142, v143
    v_add_u32 v150, s26, v152
    v_add_u32 v151, s26, v153
    v_pk_fmac_f16 v150, s27, v152
    v_pk_fmac_f16 v151, s27, v153
    v_mfma_f32_32x32x16_bf16 v[128:143], v[156:159], v[104:107], 0
    buffer_load_dwordx4 a[196:199], v2, s[4:7], s63 offen offset:2048 sc1
    v_cvt_pknorm_u16_f32 v152, v112, v113
    v_cvt_pknorm_u16_f32 v153, v114, v115
    v_add_u32 v144, s26, v152
    v_add_u32 v145, s26, v153
    v_pk_fmac_f16 v144, s27, v152
    v_pk_fmac_f16 v145, s27, v153
    v_mfma_f32_32x32x16_f16 v[48:63], v[184:187], v[148:151], v[48:63]
    v_cvt_pknorm_u16_f32 v152, v116, v117
    v_cvt_pknorm_u16_f32 v153, v118, v119
    v_add_u32 v146, s26, v152
    v_add_u32 v147, s26, v153
    v_pk_fmac_f16 v146, s27, v152
    v_pk_fmac_f16 v147, s27, v153
    v_mfma_f32_32x32x16_bf16 v[128:143], v[160:163], v[108:111], v[128:143]
    buffer_load_dwordx4 a[200:203], v2, s[4:7], s63 offen offset:3072 sc1
    v_cvt_pknorm_u16_f32 v152, v120, v121
    v_cvt_pknorm_u16_f32 v153, v122, v123
    v_add_u32 v148, s26, v152
    v_add_u32 v149, s26, v153
    v_pk_fmac_f16 v148, s27, v152
    v_pk_fmac_f16 v149, s27, v153
    v_mfma_f32_32x32x16_f16 v[64:79], v[196:199], v[144:147], v[64:79]
    ds_write_b128 v9, v[48:51] offset:0
    v_cvt_pknorm_u16_f32 v152, v124, v125
    v_cvt_pknorm_u16_f32 v153, v126, v127
    v_add_u32 v150, s26, v152
    v_add_u32 v151, s26, v153
    v_pk_fmac_f16 v150, s27, v152
    v_pk_fmac_f16 v151, s27, v153
    v_mfma_f32_32x32x16_bf16 v[112:127], v[172:175], v[80:83], 0
    global_load_dwordx4 v[104:107], v13, s[18:19]
    ds_write_b128 v9, v[52:55] offset:1024
    v_cvt_pknorm_u16_f32 v152, v128, v129
    v_cvt_pknorm_u16_f32 v153, v130, v131
    v_add_u32 v144, s26, v152
    v_add_u32 v145, s26, v153
    v_pk_fmac_f16 v144, s27, v152
    v_pk_fmac_f16 v145, s27, v153
    v_mfma_f32_32x32x16_f16 v[64:79], v[200:203], v[148:151], v[64:79]
    ds_write_b128 v9, v[56:59] offset:2048
    v_cvt_pknorm_u16_f32 v152, v132, v133
    v_cvt_pknorm_u16_f32 v153, v134, v135
    v_add_u32 v146, s26, v152
    v_add_u32 v147, s26, v153
    v_pk_fmac_f16 v146, s27, v152
    v_pk_fmac_f16 v147, s27, v153
    v_mfma_f32_32x32x16_bf16 v[112:127], v[176:179], v[84:87], v[112:127]
    global_load_dwordx3 v[108:110], v13, s[18:19] offset:16
    ds_write_b128 v9, v[60:63] offset:3072
    v_cvt_pknorm_u16_f32 v152, v136, v137
    v_cvt_pknorm_u16_f32 v153, v138, v139
    v_add_u32 v148, s26, v152
    v_add_u32 v149, s26, v153
    v_pk_fmac_f16 v148, s27, v152
    v_pk_fmac_f16 v149, s27, v153
    v_mfma_f32_32x32x16_f16 v[64:79], v[180:183], v[144:147], v[64:79]
    v_cvt_pknorm_u16_f32 v152, v140, v141
    v_cvt_pknorm_u16_f32 v153, v142, v143
    v_add_u32 v150, s26, v152
    v_add_u32 v151, s26, v153
    v_pk_fmac_f16 v150, s27, v152
    v_pk_fmac_f16 v151, s27, v153
    v_mfma_f32_32x32x16_bf16 v[128:143], v[156:159], v[80:83], 0
    buffer_load_dwordx4 a[204:207], v2, s[4:7], s64 offen offset:0 sc1
    v_cvt_pknorm_u16_f32 v152, v112, v113
    v_cvt_pknorm_u16_f32 v153, v114, v115
    v_add_u32 v144, s26, v152
    v_add_u32 v145, s26, v153
    v_pk_fmac_f16 v144, s27, v152
    v_pk_fmac_f16 v145, s27, v153
    v_mfma_f32_32x32x16_f16 v[64:79], v[184:187], v[148:151], v[64:79]
    v_cvt_pknorm_u16_f32 v152, v116, v117
    v_cvt_pknorm_u16_f32 v153, v118, v119
    v_add_u32 v146, s26, v152
    v_add_u32 v147, s26, v153
    v_pk_fmac_f16 v146, s27, v152
    v_pk_fmac_f16 v147, s27, v153
    v_mfma_f32_32x32x16_bf16 v[128:143], v[160:163], v[84:87], v[128:143]
    buffer_load_dwordx4 a[208:211], v2, s[4:7], s64 offen offset:1024 sc1
    v_cvt_pknorm_u16_f32 v152, v120, v121
    v_cvt_pknorm_u16_f32 v153, v122, v123
    v_add_u32 v148, s26, v152
    v_add_u32 v149, s26, v153
    v_pk_fmac_f16 v148, s27, v152
    v_pk_fmac_f16 v149, s27, v153
    v_mfma_f32_32x32x16_f16 v[16:31], v[196:199], v[144:147], v[16:31]
    ds_write_b128 v10, v[64:67] offset:0
    v_cvt_pknorm_u16_f32 v152, v124, v125
    v_cvt_pknorm_u16_f32 v153, v126, v127
    v_add_u32 v150, s26, v152
    v_add_u32 v151, s26, v153
    v_pk_fmac_f16 v150, s27, v152
    v_pk_fmac_f16 v151, s27, v153
    buffer_load_dwordx4 a[212:215], v2, s[4:7], s64 offen offset:2048 sc1
    ds_write_b128 v10, v[68:71] offset:1024
    v_cvt_pknorm_u16_f32 v152, v128, v129
    v_cvt_pknorm_u16_f32 v153, v130, v131
    v_add_u32 v144, s26, v152
    v_add_u32 v145, s26, v153
    v_pk_fmac_f16 v144, s27, v152
    v_pk_fmac_f16 v145, s27, v153
    v_mfma_f32_32x32x16_f16 v[16:31], v[200:203], v[148:151], v[16:31]
    ds_write_b128 v10, v[72:75] offset:2048
    v_cvt_pknorm_u16_f32 v152, v132, v133
    v_cvt_pknorm_u16_f32 v153, v134, v135
    v_add_u32 v146, s26, v152
    v_add_u32 v147, s26, v153
    v_pk_fmac_f16 v146, s27, v152
    v_pk_fmac_f16 v147, s27, v153
    buffer_load_dwordx4 a[216:219], v2, s[4:7], s64 offen offset:3072 sc1
    ds_write_b128 v10, v[76:79] offset:3072
    v_cvt_pknorm_u16_f32 v152, v136, v137
    v_cvt_pknorm_u16_f32 v153, v138, v139
    v_add_u32 v148, s26, v152
    v_add_u32 v149, s26, v153
    v_pk_fmac_f16 v148, s27, v152
    v_pk_fmac_f16 v149, s27, v153
    v_mfma_f32_32x32x16_f16 v[16:31], v[180:183], v[144:147], v[16:31]
    v_cvt_pknorm_u16_f32 v152, v140, v141
    v_cvt_pknorm_u16_f32 v153, v142, v143
    v_add_u32 v150, s26, v152
    v_add_u32 v151, s26, v153
    v_pk_fmac_f16 v150, s27, v152
    v_pk_fmac_f16 v151, s27, v153
    s_nop 1
    v_mfma_f32_32x32x16_f16 v[16:31], v[184:187], v[148:151], v[16:31]
k2_comb:
    buffer_load_dwordx4 a[220:223], v2, s[4:7], s65 offen offset:0 sc1
    buffer_load_dwordx4 a[224:227], v2, s[4:7], s65 offen offset:1024 sc1
    s_waitcnt lgkmcnt(0)
    s_barrier
    ds_read_b128 v[32:35], v11 offset:0
    ds_read_b128 v[36:39], v11 offset:1024
    ds_read_b128 v[40:43], v11 offset:2048
    ds_read_b128 v[44:47], v11 offset:3072
    buffer_load_dwordx4 a[228:231], v2, s[4:7], s65 offen offset:2048 sc1
    ds_read_b128 v[48:51], v11 offset:4096
    ds_read_b128 v[52:55], v11 offset:5120
    ds_read_b128 v[56:59], v11 offset:6144
    ds_read_b128 v[60:63], v11 offset:7168
    buffer_load_dwordx4 a[232:235], v2, s[4:7], s65 offen offset:3072 sc1
    ds_read_b128 v[64:67], v11 offset:8192
    ds_read_b128 v[68:71], v11 offset:9216
    ds_read_b128 v[72:75], v11 offset:10240
    ds_read_b128 v[76:79], v11 offset:11264
    buffer_load_dwordx4 a[236:239], v2, s[4:7], s66 offen offset:0 sc1
    s_waitcnt lgkmcnt(8)
    v_pk_add_f32 v[16:17], v[16:17], v[32:33]
    v_pk_add_f32 v[18:19], v[18:19], v[34:35]
    v_pk_add_f32 v[20:21], v[20:21], v[36:37]
    v_pk_add_f32 v[22:23], v[22:23], v[38:39]
    v_pk_add_f32 v[24:25], v[24:25], v[40:41]
    v_pk_add_f32 v[26:27], v[26:27], v[42:43]
    v_pk_add_f32 v[28:29], v[28:29], v[44:45]
    v_pk_add_f32 v[30:31], v[30:31], v[46:47]
    buffer_load_dwordx4 a[240:243], v2, s[4:7], s66 offen offset:1024 sc1
    s_waitcnt lgkmcnt(4)
    v_pk_add_f32 v[16:17], v[16:17], v[48:49]
    v_pk_add_f32 v[18:19], v[18:19], v[50:51]
    v_pk_add_f32 v[20:21], v[20:21], v[52:53]
    v_pk_add_f32 v[22:23], v[22:23], v[54:55]
    v_pk_add_f32 v[24:25], v[24:25], v[56:57]
    v_pk_add_f32 v[26:27], v[26:27], v[58:59]
    v_pk_add_f32 v[28:29], v[28:29], v[60:61]
    v_pk_add_f32 v[30:31], v[30:31], v[62:63]
    buffer_load_dwordx4 a[244:247], v2, s[4:7], s66 offen offset:2048 sc1
    s_waitcnt lgkmcnt(0)
    v_pk_add_f32 v[16:17], v[16:17], v[64:65]
    v_pk_add_f32 v[18:19], v[18:19], v[66:67]
    v_pk_add_f32 v[20:21], v[20:21], v[68:69]
    v_pk_add_f32 v[22:23], v[22:23], v[70:71]
    v_pk_add_f32 v[24:25], v[24:25], v[72:73]
    v_pk_add_f32 v[26:27], v[26:27], v[74:75]
    v_pk_add_f32 v[28:29], v[28:29], v[76:77]
    v_pk_add_f32 v[30:31], v[30:31], v[78:79]
    buffer_load_dwordx4 a[248:251], v2, s[4:7], s66 offen offset:3072 sc1
    v_mov_b32 v14, v28
    v_mov_b32 v15, v28
    s_nop 1
    v_permlane32_swap_b32 v14, v15
    v_rcp_f32 v14, v15
    v_cmp_nle_f32 vcc, 0x42800000, v15
    v_pk_mul_f32 v[16:17], v[16:17], v[14:15] op_sel_hi:[1,0]
    v_pk_mul_f32 v[18:19], v[18:19], v[14:15] op_sel_hi:[1,0]
    v_pk_mul_f32 v[20:21], v[20:21], v[14:15] op_sel_hi:[1,0]
    v_pk_mul_f32 v[22:23], v[22:23], v[14:15] op_sel_hi:[1,0]
    v_pk_mul_f32 v[24:25], v[24:25], v[14:15] op_sel_hi:[1,0]
    v_pk_mul_f32 v[26:27], v[26:27], v[14:15] op_sel_hi:[1,0]
    v_pk_mul_f32 v[28:29], v[28:29], v[14:15] op_sel_hi:[1,0]
    v_pk_mul_f32 v[30:31], v[30:31], v[14:15] op_sel_hi:[1,0]
    buffer_load_dwordx4 a[252:255], v2, s[4:7], s67 offen offset:0 sc1
    s_cmp_lg_u64 vcc, 0
    v_cmp_eq_u32 vcc, -1, v3
    s_cselect_b32 s22, 1, s31
    s_cmp_lg_u64 vcc, 0
    s_cselect_b32 s22, 2, s22
    s_andn2_b32 s22, s22, s8
    s_or_b32 s22, s22, s73
    v_mov_b32 v14, s22
    s_lshl_b32 s22, s3, 2
    v_cvt_pk_bf16_f32 v32, v16, v17
    v_cvt_pk_bf16_f32 v33, v18, v19
    v_cvt_pk_bf16_f32 v34, v20, v21
    v_cvt_pk_bf16_f32 v35, v22, v23
    v_cvt_pk_bf16_f32 v36, v24, v25
    v_cvt_pk_bf16_f32 v37, v26, v27
    v_cvt_pk_bf16_f32 v38, v28, v29
    v_cvt_pk_bf16_f32 v39, v30, v31
    v_mov_b32 v15, s22
    ds_write_b64 v4, v[32:33] offset:49152
    ds_write_b64 v4, v[34:35] offset:49168
    ds_write_b64 v4, v[36:37] offset:49184
    s_mov_b32 exec_hi, 0
    ds_write_b64 v4, v[38:39] offset:49200
    s_mov_b32 exec_lo, 1
    ds_write_b32 v15, v14 offset:58368
    s_mov_b64 exec, -1
    v_mov_b32 v15, 0
    buffer_load_dwordx4 v[112:115], v2, s[4:7], s67 offen offset:1024 sc1
    buffer_load_dwordx4 v[116:119], v2, s[4:7], s67 offen offset:2048 sc1
    s_waitcnt lgkmcnt(0)
    s_barrier
    ds_read_b128 v[72:75], v15 offset:58368
    ds_read_b128 v[16:19], v5 offset:49152
    ds_read_b128 v[20:23], v5 offset:49216
    ds_read_b128 v[24:27], v5 offset:49280
    ds_read_b128 v[28:31], v5 offset:49344
    ds_read_b128 v[32:35], v5 offset:49408
    ds_read_b128 v[36:39], v5 offset:49472
    ds_read_b128 v[40:43], v5 offset:49536
    buffer_load_dwordx4 v[120:123], v2, s[4:7], s67 offen offset:3072 sc1
    ds_read_b128 v[44:47], v5 offset:49600
    ds_read_b128 v[48:51], v5 offset:49664
    ds_read_b128 v[52:55], v5 offset:49728
    ds_read_b128 v[56:59], v5 offset:49792
    ds_read_b128 v[60:63], v5 offset:49856
    ds_read_b128 v[64:67], v5 offset:49920
    ds_read_b128 v[68:71], v5 offset:49984
    buffer_load_dwordx4 v[124:127], v2, s[4:7], s68 offen offset:0 sc1
    s_waitcnt lgkmcnt(14)
    v_or3_b32 v72, v72, v73, v74
    v_or_b32 v72, v72, v75
    s_nop 0
    v_readfirstlane_b32 s96, v72
    s_nop 0
    s_cmp_lg_u32 s96, 0
    s_cbranch_scc1 k2_slow
    s_waitcnt lgkmcnt(13)
    v_mfma_f32_16x16x32_bf16 v[80:83], v[204:207], v[16:19], 0
    v_mov_b32 v8, 0
    s_waitcnt lgkmcnt(12)
    v_mfma_f32_16x16x32_bf16 v[80:83], v[208:211], v[20:23], v[80:83]
    v_mov_b32 v9, 0
    s_waitcnt lgkmcnt(11)
    v_mfma_f32_16x16x32_bf16 v[80:83], v[212:215], v[24:27], v[80:83]
    buffer_load_dwordx4 v[128:131], v2, s[4:7], s68 offen offset:1024 sc1
    s_waitcnt lgkmcnt(10)
    v_mfma_f32_16x16x32_bf16 v[80:83], v[216:219], v[28:31], v[80:83]
    v_mov_b32 v10, 0
    s_waitcnt lgkmcnt(9)
    v_mfma_f32_16x16x32_bf16 v[80:83], v[220:223], v[32:35], v[80:83]
    v_mov_b32 v11, 0
    s_waitcnt lgkmcnt(8)
    v_mfma_f32_16x16x32_bf16 v[80:83], v[224:227], v[36:39], v[80:83]
    buffer_load_dwordx4 v[132:135], v2, s[4:7], s68 offen offset:2048 sc1
    s_waitcnt lgkmcnt(7)
    v_mfma_f32_16x16x32_bf16 v[80:83], v[228:231], v[40:43], v[80:83]
    v_and_b32 v6, 7, v0
    s_waitcnt lgkmcnt(6)
    v_mfma_f32_16x16x32_bf16 v[80:83], v[232:235], v[44:47], v[80:83]
    v_lshlrev_b32 v6, 6, v6
    s_waitcnt lgkmcnt(5)
    v_mfma_f32_16x16x32_bf16 v[80:83], v[236:239], v[48:51], v[80:83]
    buffer_load_dwordx4 v[136:139], v2, s[4:7], s68 offen offset:3072 sc1
    s_waitcnt lgkmcnt(4)
    v_mfma_f32_16x16x32_bf16 v[80:83], v[240:243], v[52:55], v[80:83]
    v_bfe_u32 v5, v0, 4, 2
    s_waitcnt lgkmcnt(3)
    v_mfma_f32_16x16x32_bf16 v[80:83], v[244:247], v[56:59], v[80:83]
    v_lshl_add_u32 v5, v5, 4, v6
    s_waitcnt lgkmcnt(2)
    v_mfma_f32_16x16x32_bf16 v[80:83], v[248:251], v[60:63], v[80:83]
    buffer_load_dwordx4 v[140:143], v2, s[4:7], s69 offen offset:0 sc1
    s_waitcnt lgkmcnt(1)
    v_mfma_f32_16x16x32_bf16 v[80:83], v[252:255], v[64:67], v[80:83]
    v_add_u32 v5, s22, v5
    s_waitcnt lgkmcnt(0)
    v_mfma_f32_16x16x32_bf16 v[80:83], a[0:3], v[68:71], v[80:83]
    v_add_u32 v4, s30, v13
    v_mfma_f32_16x16x32_bf16 v[84:87], a[4:7], v[16:19], 0
    buffer_load_dwordx4 v[152:155], v2, s[4:7], s69 offen offset:1024 sc1
    s_waitcnt vmcnt(22)
    v_mfma_f32_16x16x32_bf16 v[84:87], a[8:11], v[20:23], v[84:87]
    v_lshlrev_b32 v220, 16, v96
    v_and_b32 v221, s23, v96
    v_mfma_f32_16x16x32_bf16 v[84:87], a[12:15], v[24:27], v[84:87]
    v_lshlrev_b32 v204, 16, v104
    v_and_b32 v205, s23, v104
    v_mfma_f32_16x16x32_bf16 v[84:87], a[16:19], v[28:31], v[84:87]
    buffer_load_dwordx4 v[156:159], v2, s[4:7], s69 offen offset:2048 sc1
    v_lshlrev_b32 v222, 16, v97
    v_mfma_f32_16x16x32_bf16 v[84:87], a[20:23], v[32:35], v[84:87]
    v_and_b32 v223, s23, v97
    v_lshlrev_b32 v206, 16, v105
    v_mfma_f32_16x16x32_bf16 v[84:87], a[24:27], v[36:39], v[84:87]
    v_and_b32 v207, s23, v105
    v_lshlrev_b32 v224, 16, v98
    v_mfma_f32_16x16x32_bf16 v[84:87], a[28:31], v[40:43], v[84:87]
    buffer_load_dwordx4 v[160:163], v2, s[4:7], s69 offen offset:3072 sc1
    v_and_b32 v225, s23, v98
    v_mfma_f32_16x16x32_bf16 v[84:87], a[32:35], v[44:47], v[84:87]
    v_lshlrev_b32 v208, 16, v106
    v_and_b32 v209, s23, v106
    v_mfma_f32_16x16x32_bf16 v[84:87], a[36:39], v[48:51], v[84:87]
    v_lshlrev_b32 v226, 16, v99
    v_and_b32 v227, s23, v99
    v_mfma_f32_16x16x32_bf16 v[84:87], a[40:43], v[52:55], v[84:87]
    buffer_load_dwordx4 v[164:167], v2, s[4:7], s70 offen offset:0 sc1
    v_lshlrev_b32 v210, 16, v107
    v_mfma_f32_16x16x32_bf16 v[84:87], a[44:47], v[56:59], v[84:87]
    v_and_b32 v211, s23, v107
    v_lshlrev_b32 v228, 16, v100
    v_mfma_f32_16x16x32_bf16 v[84:87], a[48:51], v[60:63], v[84:87]
    v_and_b32 v229, s23, v100
    v_lshlrev_b32 v212, 16, v108
    v_mfma_f32_16x16x32_bf16 v[84:87], a[52:55], v[64:67], v[84:87]
    buffer_load_dwordx4 v[168:171], v2, s[4:7], s70 offen offset:1024 sc1
    v_and_b32 v213, s23, v108
    v_mfma_f32_16x16x32_bf16 v[84:87], a[56:59], v[68:71], v[84:87]
    v_lshlrev_b32 v230, 16, v101
    v_and_b32 v231, s23, v101
    v_mfma_f32_16x16x32_bf16 v[88:91], a[60:63], v[16:19], 0
    v_lshlrev_b32 v214, 16, v109
    v_and_b32 v215, s23, v109
    v_mfma_f32_16x16x32_bf16 v[88:91], a[64:67], v[20:23], v[88:91]
    buffer_load_dwordx4 v[172:175], v2, s[4:7], s70 offen offset:2048 sc1
    v_lshlrev_b32 v232, 16, v102
    v_mfma_f32_16x16x32_bf16 v[88:91], a[68:71], v[24:27], v[88:91]
    v_and_b32 v233, s23, v102
    v_lshlrev_b32 v216, 16, v110
    v_mfma_f32_16x16x32_bf16 v[88:91], a[72:75], v[28:31], v[88:91]
    v_and_b32 v217, s23, v110
    v_cvt_pk_bf16_f32 v14, v80, v81
    v_mfma_f32_16x16x32_bf16 v[88:91], a[76:79], v[32:35], v[88:91]
    buffer_load_dwordx4 v[176:179], v2, s[4:7], s70 offen offset:3072 sc1
    v_cvt_pk_bf16_f32 v15, v82, v83
    v_mfma_f32_16x16x32_bf16 v[88:91], a[80:83], v[36:39], v[88:91]
    v_cvt_pk_bf16_f32 v148, v84, v85
    v_cvt_pk_bf16_f32 v149, v86, v87
    v_mfma_f32_16x16x32_bf16 v[88:91], a[84:87], v[40:43], v[88:91]
    v_cndmask_b32 v14, v148, v14, s[24:25]
    v_cndmask_b32 v15, v149, v15, s[24:25]
    v_mfma_f32_16x16x32_bf16 v[88:91], a[88:91], v[44:47], v[88:91]
    buffer_load_dwordx4 v[180:183], v2, s[4:7], s71 offen offset:0 sc1
    v_lshlrev_b32 v80, 16, v14
    v_mfma_f32_16x16x32_bf16 v[88:91], a[92:95], v[48:51], v[88:91]
    v_and_b32 v81, s23, v14
    v_lshlrev_b32 v82, 16, v15
    v_mfma_f32_16x16x32_bf16 v[88:91], a[96:99], v[52:55], v[88:91]
    v_and_b32 v83, s23, v15
    v_add_f32 v220, v220, v80
    v_mfma_f32_16x16x32_bf16 v[88:91], a[100:103], v[56:59], v[88:91]
    buffer_load_dwordx4 v[184:187], v2, s[4:7], s71 offen offset:1024 sc1
    v_add_f32 v221, v221, v81
    v_mfma_f32_16x16x32_bf16 v[88:91], a[104:107], v[60:63], v[88:91]
    v_add_f32 v222, v222, v82
    v_add_f32 v223, v223, v83
    v_mfma_f32_16x16x32_bf16 v[88:91], a[108:111], v[64:67], v[88:91]
    v_cvt_pk_bf16_f32 v96, v220, v221
    v_cvt_pk_bf16_f32 v97, v222, v223
    v_mfma_f32_16x16x32_bf16 v[88:91], a[112:115], v[68:71], v[88:91]
    buffer_load_dwordx4 v[188:191], v2, s[4:7], s71 offen offset:2048 sc1
    v_lshlrev_b32 v220, 16, v96
    v_mfma_f32_16x16x32_bf16 v[92:95], a[116:119], v[16:19], 0
    v_and_b32 v221, s23, v96
    v_lshlrev_b32 v222, 16, v97
    v_mfma_f32_16x16x32_bf16 v[92:95], a[120:123], v[20:23], v[92:95]
    v_and_b32 v223, s23, v97
    v_add_f32 v8, v8, v220
    v_mfma_f32_16x16x32_bf16 v[92:95], a[124:127], v[24:27], v[92:95]
    buffer_load_dwordx4 v[192:195], v2, s[4:7], s71 offen offset:3072 sc1
    v_fmac_f32 v9, v220, v220
    v_mfma_f32_16x16x32_bf16 v[92:95], a[128:131], v[28:31], v[92:95]
    v_fmac_f32 v10, v220, v204
    v_add_f32 v8, v8, v221
    v_mfma_f32_16x16x32_bf16 v[92:95], a[132:135], v[32:35], v[92:95]
    v_fmac_f32 v9, v221, v221
    v_fmac_f32 v10, v221, v205
    v_mfma_f32_16x16x32_bf16 v[92:95], a[136:139], v[36:39], v[92:95]
    buffer_load_dwordx4 v[196:199], v2, s[4:7], s72 offen offset:0 sc1
    v_add_f32 v8, v8, v222
    v_mfma_f32_16x16x32_bf16 v[92:95], a[140:143], v[40:43], v[92:95]
    v_fmac_f32 v9, v222, v222
    v_fmac_f32 v10, v222, v206
    v_mfma_f32_16x16x32_bf16 v[92:95], a[144:147], v[44:47], v[92:95]
    v_add_f32 v8, v8, v223
    v_fmac_f32 v9, v223, v223
    v_mfma_f32_16x16x32_bf16 v[92:95], a[148:151], v[48:51], v[92:95]
    buffer_load_dwordx4 v[200:203], v2, s[4:7], s72 offen offset:1024 sc1
    v_fmac_f32 v10, v223, v207
    v_mfma_f32_16x16x32_bf16 v[92:95], a[152:155], v[52:55], v[92:95]
    v_add_f32 v11, v11, v204
    v_add_f32 v11, v11, v205
    v_mfma_f32_16x16x32_bf16 v[92:95], a[156:159], v[56:59], v[92:95]
    v_add_f32 v11, v11, v206
    v_add_f32 v11, v11, v207
    v_mfma_f32_16x16x32_bf16 v[92:95], a[160:163], v[60:63], v[92:95]
    buffer_load_dwordx4 v[234:237], v1, s[4:7], s74 offen offset:0 sc1
    v_add_f32 v11, v11, v208
    v_mfma_f32_16x16x32_bf16 v[92:95], a[164:167], v[64:67], v[92:95]
    v_add_f32 v11, v11, v209
    v_add_f32 v11, v11, v210
    v_mfma_f32_16x16x32_bf16 v[92:95], a[168:171], v[68:71], v[92:95]
    v_add_f32 v11, v11, v211
    v_add_f32 v11, v11, v212
    v_mfma_f32_16x16x32_bf16 v[72:75], a[172:175], v[16:19], 0
    buffer_load_dwordx4 v[238:241], v1, s[4:7], s75 offen offset:0 sc1
    v_add_f32 v11, v11, v213
    v_mfma_f32_16x16x32_bf16 v[72:75], a[176:179], v[20:23], v[72:75]
    v_add_f32 v11, v11, v214
    v_add_f32 v11, v11, v215
    v_mfma_f32_16x16x32_bf16 v[72:75], a[180:183], v[24:27], v[72:75]
    v_add_f32 v11, v11, v216
    v_add_f32 v11, v11, v217
    v_mfma_f32_16x16x32_bf16 v[72:75], a[184:187], v[28:31], v[72:75]
    buffer_load_dwordx4 v[242:245], v1, s[4:7], s74 offen offset:1024 sc1
    v_cvt_pk_bf16_f32 v14, v88, v89
    v_mfma_f32_16x16x32_bf16 v[72:75], a[188:191], v[32:35], v[72:75]
    v_cvt_pk_bf16_f32 v15, v90, v91
    v_cvt_pk_bf16_f32 v148, v92, v93
    v_mfma_f32_16x16x32_bf16 v[72:75], a[192:195], v[36:39], v[72:75]
    v_cvt_pk_bf16_f32 v149, v94, v95
    v_cndmask_b32 v14, v148, v14, s[24:25]
    v_mfma_f32_16x16x32_bf16 v[72:75], a[196:199], v[40:43], v[72:75]
    buffer_load_dwordx4 v[246:249], v1, s[4:7], s75 offen offset:1024 sc1
    v_cndmask_b32 v15, v149, v15, s[24:25]
    v_mfma_f32_16x16x32_bf16 v[72:75], a[200:203], v[44:47], v[72:75]
    v_lshlrev_b32 v88, 16, v14
    v_and_b32 v89, s23, v14
    s_waitcnt vmcnt(37)
    v_mfma_f32_16x16x32_bf16 v[72:75], a[204:207], v[48:51], v[72:75]
    v_lshlrev_b32 v90, 16, v15
    v_and_b32 v91, s23, v15
    s_waitcnt vmcnt(36)
    v_mfma_f32_16x16x32_bf16 v[72:75], a[208:211], v[52:55], v[72:75]
    v_add_f32 v224, v224, v88
    v_add_f32 v225, v225, v89
    s_waitcnt vmcnt(35)
    v_mfma_f32_16x16x32_bf16 v[72:75], a[212:215], v[56:59], v[72:75]
    v_add_f32 v226, v226, v90
    v_add_f32 v227, v227, v91
    s_waitcnt vmcnt(34)
    v_mfma_f32_16x16x32_bf16 v[72:75], a[216:219], v[60:63], v[72:75]
    v_cvt_pk_bf16_f32 v98, v224, v225
    v_cvt_pk_bf16_f32 v99, v226, v227
    s_waitcnt vmcnt(33)
    v_mfma_f32_16x16x32_bf16 v[72:75], a[220:223], v[64:67], v[72:75]
    v_lshlrev_b32 v224, 16, v98
    v_and_b32 v225, s23, v98
    s_waitcnt vmcnt(32)
    v_mfma_f32_16x16x32_bf16 v[72:75], a[224:227], v[68:71], v[72:75]
    v_lshlrev_b32 v226, 16, v99
    v_and_b32 v227, s23, v99
    s_waitcnt vmcnt(31)
    v_mfma_f32_16x16x32_bf16 v[76:79], a[228:231], v[16:19], 0
    v_add_f32 v8, v8, v224
    v_fmac_f32 v9, v224, v224
    s_waitcnt vmcnt(30)
    v_mfma_f32_16x16x32_bf16 v[76:79], a[232:235], v[20:23], v[76:79]
    v_fmac_f32 v10, v224, v208
    v_add_f32 v8, v8, v225
    s_waitcnt vmcnt(29)
    v_mfma_f32_16x16x32_bf16 v[76:79], a[236:239], v[24:27], v[76:79]
    v_fmac_f32 v9, v225, v225
    v_fmac_f32 v10, v225, v209
    s_waitcnt vmcnt(28)
    v_mfma_f32_16x16x32_bf16 v[76:79], a[240:243], v[28:31], v[76:79]
    v_add_f32 v8, v8, v226
    v_fmac_f32 v9, v226, v226
    s_waitcnt vmcnt(27)
    v_mfma_f32_16x16x32_bf16 v[76:79], a[244:247], v[32:35], v[76:79]
    v_fmac_f32 v10, v226, v210
    v_add_f32 v8, v8, v227
    s_waitcnt vmcnt(26)
    v_mfma_f32_16x16x32_bf16 v[76:79], a[248:251], v[36:39], v[76:79]
    v_fmac_f32 v9, v227, v227
    v_fmac_f32 v10, v227, v211
    s_waitcnt vmcnt(25)
    v_mfma_f32_16x16x32_bf16 v[76:79], a[252:255], v[40:43], v[76:79]
    s_waitcnt vmcnt(24)
    v_mfma_f32_16x16x32_bf16 v[76:79], v[112:115], v[44:47], v[76:79]
    s_waitcnt vmcnt(23)
    v_mfma_f32_16x16x32_bf16 v[76:79], v[116:119], v[48:51], v[76:79]
    s_waitcnt vmcnt(22)
    v_mfma_f32_16x16x32_bf16 v[76:79], v[120:123], v[52:55], v[76:79]
    s_waitcnt vmcnt(21)
    v_mfma_f32_16x16x32_bf16 v[76:79], v[124:127], v[56:59], v[76:79]
    s_waitcnt vmcnt(20)
    v_mfma_f32_16x16x32_bf16 v[76:79], v[128:131], v[60:63], v[76:79]
    s_waitcnt vmcnt(19)
    v_mfma_f32_16x16x32_bf16 v[76:79], v[132:135], v[64:67], v[76:79]
    s_waitcnt vmcnt(18)
    v_mfma_f32_16x16x32_bf16 v[76:79], v[136:139], v[68:71], v[76:79]
    s_waitcnt vmcnt(17)
    v_mfma_f32_16x16x32_bf16 v[144:147], v[140:143], v[16:19], 0
    s_waitcnt vmcnt(16)
    v_mfma_f32_16x16x32_bf16 v[144:147], v[152:155], v[20:23], v[144:147]
    s_waitcnt vmcnt(15)
    v_mfma_f32_16x16x32_bf16 v[144:147], v[156:159], v[24:27], v[144:147]
    v_cvt_pk_bf16_f32 v14, v72, v73
    v_cvt_pk_bf16_f32 v15, v74, v75
    s_waitcnt vmcnt(14)
    v_mfma_f32_16x16x32_bf16 v[144:147], v[160:163], v[28:31], v[144:147]
    v_cvt_pk_bf16_f32 v148, v76, v77
    v_cvt_pk_bf16_f32 v149, v78, v79
    s_waitcnt vmcnt(13)
    v_mfma_f32_16x16x32_bf16 v[144:147], v[164:167], v[32:35], v[144:147]
    v_cndmask_b32 v14, v148, v14, s[24:25]
    v_cndmask_b32 v15, v149, v15, s[24:25]
    s_waitcnt vmcnt(12)
    v_mfma_f32_16x16x32_bf16 v[144:147], v[168:171], v[36:39], v[144:147]
    v_lshlrev_b32 v72, 16, v14
    v_and_b32 v73, s23, v14
    s_waitcnt vmcnt(11)
    v_mfma_f32_16x16x32_bf16 v[144:147], v[172:175], v[40:43], v[144:147]
    v_lshlrev_b32 v74, 16, v15
    v_and_b32 v75, s23, v15
    s_waitcnt vmcnt(10)
    v_mfma_f32_16x16x32_bf16 v[144:147], v[176:179], v[44:47], v[144:147]
    v_add_f32 v228, v228, v72
    v_add_f32 v229, v229, v73
    s_waitcnt vmcnt(9)
    v_mfma_f32_16x16x32_bf16 v[144:147], v[180:183], v[48:51], v[144:147]
    v_add_f32 v230, v230, v74
    v_add_f32 v231, v231, v75
    s_waitcnt vmcnt(8)
    v_mfma_f32_16x16x32_bf16 v[144:147], v[184:187], v[52:55], v[144:147]
    v_cvt_pk_bf16_f32 v100, v228, v229
    v_cvt_pk_bf16_f32 v101, v230, v231
    s_waitcnt vmcnt(7)
    v_mfma_f32_16x16x32_bf16 v[144:147], v[188:191], v[56:59], v[144:147]
    v_lshlrev_b32 v228, 16, v100
    v_and_b32 v229, s23, v100
    s_waitcnt vmcnt(6)
    v_mfma_f32_16x16x32_bf16 v[144:147], v[192:195], v[60:63], v[144:147]
    v_lshlrev_b32 v230, 16, v101
    v_and_b32 v231, s23, v101
    s_waitcnt vmcnt(5)
    v_mfma_f32_16x16x32_bf16 v[144:147], v[196:199], v[64:67], v[144:147]
    v_add_f32 v8, v8, v228
    v_fmac_f32 v9, v228, v228
    s_waitcnt vmcnt(4)
    v_mfma_f32_16x16x32_bf16 v[144:147], v[200:203], v[68:71], v[144:147]
    v_fmac_f32 v10, v228, v212
    v_add_f32 v8, v8, v229
    v_fmac_f32 v9, v229, v229
    v_fmac_f32 v10, v229, v213
    v_add_f32 v8, v8, v230
    v_fmac_f32 v9, v230, v230
    v_fmac_f32 v10, v230, v214
    v_add_f32 v8, v8, v231
    v_fmac_f32 v9, v231, v231
    v_fmac_f32 v10, v231, v215
    v_cvt_pk_bf16_f32 v14, v144, v145
    v_cvt_pk_bf16_f32 v15, v146, v147
    v_cndmask_b32 v14, v15, v14, s[24:25]
    v_lshlrev_b32 v144, 16, v14
    v_and_b32 v145, s23, v14
    v_add_f32 v232, v232, v144
    v_add_f32 v233, v233, v145
    v_cvt_pk_bf16_f32 v102, v232, v233
    v_lshlrev_b32 v232, 16, v102
    v_and_b32 v233, s23, v102
    v_add_f32 v8, v8, v232
    v_fmac_f32 v9, v232, v232
    v_fmac_f32 v10, v232, v216
    v_add_f32 v8, v8, v233
    v_fmac_f32 v9, v233, v233
    v_fmac_f32 v10, v233, v217
    s_nop 0
    v_permlane32_swap_b32 v8, v9
    v_permlane32_swap_b32 v10, v11
    v_add_f32 v8, v8, v9
    v_add_f32 v10, v10, v11
    s_nop 1
    v_permlane16_swap_b32 v8, v10
    v_add_f32 v8, v8, v10
    s_nop 1
    v_add_f32_dpp v8, v8, v8 row_ror:8 row_mask:0xf bank_mask:0xf
    ds_write_b32 v5, v8 offset:57600
    s_waitcnt lgkmcnt(0)
    s_barrier
    ds_read_b128 v[16:19], v6 offset:57600
    ds_read_b128 v[24:27], v6 offset:57632
    ds_read_b128 v[20:23], v6 offset:57616
    ds_read_b128 v[28:31], v6 offset:57648
    s_lshl4_add_u32 s96, s28, 13041664
    v_lshl_add_u32 v14, v0, 12, s96
    s_and_b32 s96, s2, 7
    s_lshl_b32 s96, s96, 12
    s_add_u32 s96, s96, 13041664
    v_lshl_add_u32 v46, v0, 4, s96
    v_add_u32 v15, 0x700, v4
    s_mov_b32 s22, 0xffffe000
    s_waitcnt lgkmcnt(3)
    v_pk_add_f32 v[16:17], v[16:17], v[18:19]
    v_add_f32 v16, v16, v17
    v_mul_f32 v16, s29, v16
    v_cvt_pk_bf16_f32 v8, v16, v16
    v_mul_f32 v16, v16, v16
    v_lshlrev_b32 v8, 16, v8
    s_waitcnt lgkmcnt(2)
    v_pk_add_f32 v[24:25], v[24:25], v[26:27]
    v_add_f32 v24, v24, v25
    v_fma_f32 v24, v24, s29, -v16
    v_max_f32 v24, 0, v24
    v_cvt_pk_bf16_f32 v24, v24, v24
    v_lshlrev_b32 v24, 16, v24
    v_add_f32 v24, 0x3727c5ac, v24
    v_cvt_pk_bf16_f32 v24, v24, v24
    v_lshlrev_b32 v24, 16, v24
    v_sqrt_f32 v24, v24
    s_waitcnt lgkmcnt(0)
    v_pk_add_f32 v[20:21], v[20:21], v[22:23]
    v_pk_add_f32 v[28:29], v[28:29], v[30:31]
    v_cvt_pk_bf16_f32 v24, v24, v24
    v_add_f32 v20, v20, v21
    v_lshlrev_b32 v24, 16, v24
    v_add_f32 v28, v28, v29
    v_rcp_f32 v10, v24
    v_fma_f32 v20, -v8, v28, v20
    v_mul_f32 v20, v20, v10
    v_cmp_u_f32 s[96:97], v20, v20
    v_and_or_b32 v20, v20, s22, v12
    v_pk_add_f32 v[32:33], v[220:221], v[8:9] op_sel_hi:[1,0] neg_lo:[0,1] neg_hi:[0,1]
    v_pk_add_f32 v[34:35], v[222:223], v[8:9] op_sel_hi:[1,0] neg_lo:[0,1] neg_hi:[0,1]
    v_mov_b32_dpp v21, v20 row_ror:1 row_mask:0xf bank_mask:0xf
    v_max_f32 v24, v20, v21
    v_min_f32 v25, v20, v21
    v_pk_add_f32 v[36:37], v[224:225], v[8:9] op_sel_hi:[1,0] neg_lo:[0,1] neg_hi:[0,1]
    v_pk_add_f32 v[38:39], v[226:227], v[8:9] op_sel_hi:[1,0] neg_lo:[0,1] neg_hi:[0,1]
    v_mov_b32_dpp v21, v24 row_ror:2 row_mask:0xf bank_mask:0xf
    v_pk_add_f32 v[40:41], v[228:229], v[8:9] op_sel_hi:[1,0] neg_lo:[0,1] neg_hi:[0,1]
    v_pk_add_f32 v[42:43], v[230:231], v[8:9] op_sel_hi:[1,0] neg_lo:[0,1] neg_hi:[0,1]
    v_max_f32_dpp v25, v25, v25 row_ror:2 row_mask:0xf bank_mask:0xf
    v_med3_f32 v25, v24, v21, v25
    v_max_f32 v24, v24, v21
    v_pk_add_f32 v[44:45], v[232:233], v[8:9] op_sel_hi:[1,0] neg_lo:[0,1] neg_hi:[0,1]
    v_cvt_pk_bf16_f32 v104, v32, v33
    v_mov_b32_dpp v21, v24 row_ror:4 row_mask:0xf bank_mask:0xf
    v_cvt_pk_bf16_f32 v105, v34, v35
    v_cvt_pk_bf16_f32 v106, v36, v37
    v_max_f32_dpp v25, v25, v25 row_ror:4 row_mask:0xf bank_mask:0xf
    v_med3_f32 v25, v24, v21, v25
    v_max_f32 v24, v24, v21
    v_cmp_ge_f32 vcc, v20, v25
    v_cvt_pk_bf16_f32 v107, v38, v39
    v_cvt_pk_bf16_f32 v108, v40, v41
    v_cvt_pk_bf16_f32 v109, v42, v43
    v_cvt_pk_bf16_f32 v110, v44, v45
    v_mov_b32 v28, s12
    v_mov_b32 v29, s13
    s_cmp_lg_u64 s[96:97], 0
    s_cbranch_scc1 k2_nan
k2_nan_ok:
    global_load_dwordx4 v[48:51], v46, s[14:15] sc1
    v_or_b32 v27, 0x800, v25
    v_cmp_gt_f32 s[26:27], v24, v20
    v_max_f32 v26, v24, v27
    v_min_f32 v27, v24, v27
    s_cmp_eq_u32 s3, 0
    s_cselect_b32 exec_lo, 255, 0
    s_mov_b32 exec_hi, 0
    global_store_dwordx4 v14, v[26:29], s[14:15] sc1
    s_mov_b64 s[30:31], vcc
    s_mov_b64 exec, vcc
    v_cndmask_b32 v4, v4, v15, s[26:27]
    s_mov_b64 exec, -1
    v_lshlrev_b32 v32, 16, v104
    v_and_b32 v33, s23, v104
    v_lshlrev_b32 v34, 16, v105
    v_and_b32 v35, s23, v105
    v_lshlrev_b32 v36, 16, v106
    v_and_b32 v37, s23, v106
    v_lshlrev_b32 v38, 16, v107
    v_and_b32 v39, s23, v107
    v_lshlrev_b32 v40, 16, v108
    v_and_b32 v41, s23, v108
    v_lshlrev_b32 v42, 16, v109
    v_and_b32 v43, s23, v109
    v_lshlrev_b32 v44, 16, v110
    v_and_b32 v45, s23, v110
    v_pk_mul_f32 v[32:33], v[32:33], v[10:11] op_sel_hi:[1,0]
    v_pk_mul_f32 v[34:35], v[34:35], v[10:11] op_sel_hi:[1,0]
    v_pk_mul_f32 v[36:37], v[36:37], v[10:11] op_sel_hi:[1,0]
    v_pk_mul_f32 v[38:39], v[38:39], v[10:11] op_sel_hi:[1,0]
    v_pk_mul_f32 v[40:41], v[40:41], v[10:11] op_sel_hi:[1,0]
    v_pk_mul_f32 v[42:43], v[42:43], v[10:11] op_sel_hi:[1,0]
    v_pk_mul_f32 v[44:45], v[44:45], v[10:11] op_sel_hi:[1,0]
    v_cvt_pk_bf16_f32 v104, v32, v33
    v_cvt_pk_bf16_f32 v105, v34, v35
    v_cvt_pk_bf16_f32 v106, v36, v37
    v_cvt_pk_bf16_f32 v107, v38, v39
    v_cvt_pk_bf16_f32 v108, v40, v41
    v_cvt_pk_bf16_f32 v109, v42, v43
    v_cvt_pk_bf16_f32 v110, v44, v45
    s_mov_b64 exec, s[30:31]
    global_store_dwordx4 v4, v[104:107], s[14:15] offset:896 sc1
    global_store_dwordx3 v4, v[108:110], s[14:15] offset:912 sc1
    global_store_dwordx4 v4, v[96:99], s[14:15] sc1
    global_store_dwordx3 v4, v[100:102], s[14:15] offset:16 sc1
    s_mov_b64 exec, -1
    v_lshlrev_b32 v32, 16, v104
    v_and_b32 v33, s23, v104
    v_lshlrev_b32 v34, 16, v105
    v_and_b32 v35, s23, v105
    v_lshlrev_b32 v36, 16, v106
    v_and_b32 v37, s23, v106
    v_lshlrev_b32 v38, 16, v107
    v_and_b32 v39, s23, v107
    v_lshlrev_b32 v40, 16, v108
    v_and_b32 v41, s23, v108
    v_lshlrev_b32 v42, 16, v109
    v_and_b32 v43, s23, v109
    v_lshlrev_b32 v44, 16, v110
    v_and_b32 v45, s23, v110
    v_pk_add_f32 v[32:33], v[32:33], v[220:221]
    v_pk_add_f32 v[34:35], v[34:35], v[222:223]
    v_pk_add_f32 v[36:37], v[36:37], v[224:225]
    v_pk_add_f32 v[38:39], v[38:39], v[226:227]
    v_pk_add_f32 v[40:41], v[40:41], v[228:229]
    v_pk_add_f32 v[42:43], v[42:43], v[230:231]
    v_pk_add_f32 v[44:45], v[44:45], v[232:233]
    v_cvt_pk_bf16_f32 v80, v32, v33
    v_cvt_pk_bf16_f32 v81, v34, v35
    v_cvt_pk_bf16_f32 v82, v36, v37
    v_cvt_pk_bf16_f32 v83, v38, v39
    v_cvt_pk_bf16_f32 v84, v40, v41
    v_cvt_pk_bf16_f32 v85, v42, v43
    v_cvt_pk_bf16_f32 v86, v44, v45
    s_not_b64 exec, s[30:31]
    global_store_dwordx4 v7, v[80:83], s[20:21]
    global_store_dwordx3 v7, v[84:86], s[20:21] offset:16
    s_mov_b64 exec, -1
    s_cmp_lg_u32 s77, 0
    s_cbranch_scc1 k2_solo2
k2_solo2r:
    s_lshl_b32 s12, s76, 5
    s_cmp_lt_u32 s2, 224
    s_cbranch_scc1 k2_w_done
    s_waitcnt vmcnt(7)
    s_add_u32 s96, s74, 3072
    s_add_u32 s97, s75, 3072
    buffer_load_dwordx4 v[160:163], v1, s[4:7], s74 offen offset:2048 sc1
    buffer_load_dwordx4 v[164:167], v1, s[4:7], s75 offen offset:2048 sc1
    buffer_load_dwordx4 v[168:171], v1, s[4:7], s96 offen offset:0 sc1
    buffer_load_dwordx4 v[172:175], v1, s[4:7], s97 offen offset:0 sc1
    buffer_load_dwordx4 v[176:179], v1, s[4:7], s96 offen offset:1024 sc1
    buffer_load_dwordx4 v[180:183], v1, s[4:7], s97 offen offset:1024 sc1
    buffer_load_dwordx4 v[184:187], v1, s[4:7], s96 offen offset:2048 sc1
    buffer_load_dwordx4 v[188:191], v1, s[4:7], s97 offen offset:2048 sc1
    buffer_load_dwordx4 v[192:195], v1, s[4:7], s96 offen offset:3072 sc1
    buffer_load_dwordx4 v[196:199], v1, s[4:7], s97 offen offset:3072 sc1
    v_mov_b32 v144, v234
    v_mov_b32 v145, v235
    v_mov_b32 v146, v236
    v_mov_b32 v147, v237
    v_mov_b32 v148, v238
    v_mov_b32 v149, v239
    v_mov_b32 v150, v240
    v_mov_b32 v151, v241
    v_mov_b32 v152, v242
    v_mov_b32 v153, v243
    v_mov_b32 v154, v244
    v_mov_b32 v155, v245
    v_mov_b32 v156, v246
    v_mov_b32 v157, v247
    v_mov_b32 v158, v248
    v_mov_b32 v159, v249
k2_w_done:
    v_mov_b32 v128, 0
    v_mov_b32 v129, 0
    v_mov_b32 v130, 0
    v_mov_b32 v131, 0
    v_mov_b32 v132, 0
    v_mov_b32 v133, 0
    v_mov_b32 v134, 0
    v_mov_b32 v135, 0
    v_cmp_eq_u32 s[26:27], s28, v0
    s_lshl_b32 s97, s3, 8
    s_add_u32 s97, s97, 4195200
    v_bfe_u32 v72, v0, 1, 1
    v_lshl_add_u32 v64, v72, 4, s97
    v_bfe_u32 v72, v0, 4, 2
    v_lshl_add_u32 v64, v72, 5, v64
    s_lshl_b32 s97, s3, 6
    v_lshl_add_u32 v65, v72, 4, s97
    v_and_b32 v72, 1, v0
    v_lshl_add_u32 v65, v72, 8, v65
    v_and_b32 v72, 7, v0
    v_lshlrev_b32 v66, 2, v72
    v_bfe_u32 v72, v0, 3, 1
    v_lshl_add_u32 v66, v72, 8, v66
    v_lshlrev_b32 v67, 4, v72
    v_bfe_u32 v72, v0, 4, 1
    v_lshl_add_u32 v66, v72, 7, v66
    v_bfe_u32 v72, v0, 5, 1
    v_lshl_add_u32 v66, v72, 9, v66
    v_add_u32 v66, 60928, v66
    s_lshl_b32 s97, s3, 3
    v_mov_b32 v73, s97
    v_mov_b32 v74, 0
    s_movk_i32 s22, 448
    s_movk_i32 s29, 1792
    s_movk_i32 s13, 256
    s_cmp_ge_u32 s2, 224
    s_cbranch_scc1 k2_kp_check
    s_waitcnt vmcnt(7)
k2_kp_check:
    v_cmp_le_u64 vcc, s[80:81], v[50:51]
    v_cmp_ge_u64 s[96:97], s[82:83], v[50:51]
    v_cndmask_b32 v48, v48, v26, s[26:27]
    v_cndmask_b32 v49, v49, v27, s[26:27]
    s_and_b64 vcc, vcc, s[96:97]
    s_or_b64 vcc, vcc, s[26:27]
    s_cmp_eq_u64 vcc, -1
    s_cbranch_scc1 k2_kp_done
    global_load_dwordx4 v[48:51], v46, s[14:15] sc1
    s_memrealtime s[82:83]
    s_sub_u32 s13, s13, 1
    s_waitcnt vmcnt(0) lgkmcnt(0)
    s_cbranch_scc0 k2_kp_check
    v_mov_b32 v48, 0
    s_branch k2_kp_x
k2_kp_done:
    v_mov_b32_dpp v72, v48 row_ror:1 row_mask:0xf bank_mask:0xf
    v_max_f32_dpp v49, v49, v49 row_ror:1 row_mask:0xf bank_mask:0xf
    v_med3_f32 v49, v48, v72, v49
    v_max_f32 v48, v48, v72
    s_nop 1
    v_mov_b32_dpp v72, v48 row_ror:2 row_mask:0xf bank_mask:0xf
    v_max_f32_dpp v49, v49, v49 row_ror:2 row_mask:0xf bank_mask:0xf
    v_med3_f32 v49, v48, v72, v49
    v_max_f32 v48, v48, v72
    s_nop 1
    v_mov_b32_dpp v72, v48 row_ror:4 row_mask:0xf bank_mask:0xf
    v_max_f32_dpp v49, v49, v49 row_ror:4 row_mask:0xf bank_mask:0xf
    v_med3_f32 v49, v48, v72, v49
    v_max_f32 v48, v48, v72
    s_nop 1
    v_mov_b32_dpp v72, v48 row_ror:8 row_mask:0xf bank_mask:0xf
    v_max_f32_dpp v49, v49, v49 row_ror:8 row_mask:0xf bank_mask:0xf
    v_med3_f32 v49, v48, v72, v49
    v_max_f32 v48, v48, v72
    v_mov_b32 v72, v48
    v_mov_b32 v75, v49
    s_nop 0
    v_permlane16_swap_b32 v48, v72
    v_permlane16_swap_b32 v49, v75
    v_max_f32 v49, v49, v75
    v_med3_f32 v49, v48, v72, v49
    v_max_f32 v48, v48, v72
    v_mov_b32 v72, v48
    v_mov_b32 v75, v49
    s_nop 0
    v_permlane32_swap_b32 v48, v72
    v_permlane32_swap_b32 v49, v75
    v_max_f32 v49, v49, v75
    v_med3_f32 v49, v48, v72, v49
    v_max_f32 v48, v48, v72
k2_kp_x:
    ds_write_b64 v73, v[48:49] offset:60672
    s_waitcnt lgkmcnt(0)
    s_barrier
    ds_read_b128 v[48:51], v74 offset:60672
    ds_read_b128 v[52:55], v74 offset:60688
    s_waitcnt lgkmcnt(0)
    v_min_u32 v72, v48, v50
    v_max_f32 v9, v49, v51
    v_min3_u32 v72, v72, v52, v54
    v_max_f32 v75, v53, v55
    v_readfirstlane_b32 s96, v72
    v_med3_f32 v9, v48, v50, v9
    v_max_f32 v8, v48, v50
    v_med3_f32 v75, v52, v54, v75
    v_max_f32 v72, v52, v54
    s_cmp_eq_u32 s96, 0
    s_cbranch_scc1 k2_fail
    v_max_f32 v9, v9, v75
    v_med3_f32 v9, v8, v72, v9
    v_max_f32 v8, v8, v72
    s_mov_b32 s10, 0xaaaaaaaa
    s_mov_b32 s11, 0xaaaaaaaa
    s_cmp_ge_u32 s2, 224
    s_cbranch_scc1 k2_dn
    v_cndmask_b32 v72, v8, v9, s[10:11]
    v_and_b32 v75, 0x7f8, v72
    v_bfe_u32 v76, v72, 11, 1
    v_mad_u32_u24 v77, v75, s22, v64
    v_mad_u32_u24 v77, v76, s29, v77
    s_mov_b32 exec_lo, 0x000f000f
    s_mov_b32 exec_hi, 0x000f000f
    global_load_dwordx4 v[128:131], v77, s[14:15] sc1
    s_cmp_lt_u32 s3, 3
    s_cselect_b64 exec, exec, 0
    global_load_dwordx4 v[132:135], v77, s[14:15] offset:128 sc1
    s_mov_b64 exec, -1
    v_and_b32 v75, 0x17ff, v8
    v_and_b32 v76, 0x17ff, v9
    v_cmp_ne_u32 vcc, v75, v12
    v_cmp_ne_u32 s[26:27], v76, v12
    s_and_b64 vcc, vcc, s[30:31]
    s_and_b64 exec, vcc, s[26:27]
    global_store_dwordx4 v7, v[80:83], s[20:21]
    global_store_dwordx3 v7, v[84:86], s[20:21] offset:16
    s_mov_b64 exec, -1
    s_movk_i32 s13, 256
    s_waitcnt vmcnt(2)
    s_branch k2_gu_chk
k2_gu_ld:
    s_mov_b32 exec_lo, 0x000f000f
    s_mov_b32 exec_hi, 0x000f000f
    global_load_dwordx4 v[128:131], v77, s[14:15] sc1
    s_cmp_lt_u32 s3, 3
    s_cselect_b64 exec, exec, 0
    global_load_dwordx4 v[132:135], v77, s[14:15] offset:128 sc1
    s_mov_b64 exec, -1
    s_waitcnt vmcnt(0)
k2_gu_chk:
    s_cmp_lt_u32 s3, 3
    v_mfma_f32_16x16x32_bf16 v[136:139], v[234:237], v[128:131], 0
    v_mfma_f32_16x16x32_bf16 v[140:143], v[238:241], v[128:131], 0
    s_cbranch_scc0 k2_gu_w3
    v_mfma_f32_16x16x32_bf16 v[136:139], v[242:245], v[132:135], v[136:139]
    v_mfma_f32_16x16x32_bf16 v[140:143], v[246:249], v[132:135], v[140:143]
k2_gu_w3:
    v_max3_u32 v72, v128, v129, v130
    v_max3_u32 v75, v131, v132, v133
    v_max3_u32 v72, v72, v134, v135
    v_max_u32 v72, v72, v75
    v_cmp_eq_u32 vcc, -1, v72
    s_lshl_b32 s96, s101, 5
    s_add_u32 s96, s96, 5111808
    v_add_u32 v78, s96, v67
    s_cmp_eq_u64 vcc, 0
    s_cbranch_scc1 k2_gu_ok
    s_sub_u32 s13, s13, 1
    s_cbranch_scc0 k2_gu_ld
k2_gu_ok:
    s_mov_b32 exec_lo, 0x00030003
    s_mov_b32 exec_hi, 0x000c000c
    ds_write_b128 v65, v[136:139] offset:60928
    ds_write_b128 v65, v[140:143] offset:61440
    s_mov_b64 exec, -1
    s_waitcnt lgkmcnt(0)
    s_barrier
    s_cmp_eq_u32 s3, 0
    s_cbranch_scc0 k2_gu_end
    ds_read2_b32 v[72:73], v66 offset0:0 offset1:8
    ds_read2_b32 v[74:75], v66 offset0:16 offset1:24
    s_waitcnt lgkmcnt(0)
    v_pk_add_f32 v[72:73], v[72:73], v[74:75]
    v_add_f32 v72, v72, v73
    v_mov_b32 v73, v72
    s_nop 1
    v_permlane16_swap_b32 v72, v73
    v_add_f32 v72, v72, v73
    v_mov_b32 v73, v72
    s_nop 1
    v_permlane32_swap_b32 v72, v73
    v_cvt_pk_bf16_f32 v72, v72, v73
    v_lshlrev_b32 v73, 16, v72
    v_and_b32 v74, s23, v72
    v_mul_f32 v72, 0xbfb8aa3b, v73
    v_exp_f32 v72, v72
    s_nop 0
    v_add_f32 v72, 1.0, v72
    v_rcp_f32 v72, v72
    s_nop 0
    v_mul_f32 v72, v72, v73
    v_cvt_pk_bf16_f32 v72, v72, v72
    v_lshlrev_b32 v72, 16, v72
    v_mul_f32 v72, v72, v74
    s_nop 1
    v_mov_b32_dpp v73, v72 quad_perm:[1,1,3,3] row_mask:0xf bank_mask:0xf
    v_cvt_pk_bf16_f32 v72, v72, v73
    v_min_u32 v72, -2, v72
    s_nop 1
    v_mov_b32_dpp v73, v72 row_shl:2 row_mask:0xf bank_mask:0xf
    v_mov_b32_dpp v74, v72 row_shl:4 row_mask:0xf bank_mask:0xf
    v_mov_b32_dpp v75, v72 row_shl:6 row_mask:0xf bank_mask:0xf
    s_mov_b64 exec, 0x101
    global_store_dwordx4 v78, v[72:75], s[14:15] sc1
    s_mov_b64 exec, -1
k2_gu_end:
    s_branch k2_fin
k2_dn:
    s_mov_b32 s26, 0xffff0000
    s_mov_b32 s27, 0xffff0000
    v_and_b32 v100, 15, v0
    v_lshl_add_u32 v100, v100, 1, s12
    v_add_u32 v99, 4194304, v100
    v_cndmask_b32 v72, v8, v9, s[26:27]
    v_and_b32 v75, 0x7f8, v72
    v_bfe_u32 v76, v72, 11, 1
    v_mad_u32_u24 v99, v75, s22, v99
    v_mad_u32_u24 v99, v76, s29, v99
    v_and_b32 v75, 0x7ff, v72
    s_movk_i32 s96, 0x380
    v_mad_u32_u24 v100, v75, s96, v100
    v_cvt_pk_bf16_f32 v103, v72, v72
    v_lshlrev_b32 v103, 16, v103
    v_mul_f32 v103, 0xbfb8aa3b, v103
    v_exp_f32 v103, v103
    s_nop 0
    v_add_f32 v103, 1.0, v103
    v_rcp_f32 v103, v103
    s_nop 0
    v_cvt_pk_bf16_f32 v103, v103, v103
    v_lshlrev_b32 v103, 16, v103
    v_and_b32 v75, 0x17ff, v8
    v_and_b32 v76, 0x17ff, v9
    v_cmp_ne_u32 vcc, v75, v12
    v_cmp_ne_u32 s[26:27], v76, v12
    s_and_b64 vcc, vcc, s[30:31]
    s_and_b64 exec, vcc, s[26:27]
    global_store_dwordx4 v7, v[80:83], s[20:21]
    global_store_dwordx3 v7, v[84:86], s[20:21] offset:16
    s_mov_b64 exec, -1
    s_cmp_ge_u32 s12, 896
    s_cbranch_scc1 k2_fin
    s_mul_i32 s96, s3, 1792
    s_add_u32 s96, s96, 5111808
    v_and_b32 v72, 3, v0
    v_lshl_add_u32 v96, v72, 4, s96
    v_bfe_u32 v72, v0, 4, 2
    v_lshl_add_u32 v96, v72, 6, v96
    s_lshl_b32 s96, s3, 7
    v_and_b32 v72, 1, v0
    v_lshl_add_u32 v97, v72, 9, s96
    v_bfe_u32 v72, v0, 1, 1
    v_lshl_add_u32 v97, v72, 6, v97
    v_bfe_u32 v72, v0, 4, 1
    v_lshl_add_u32 v97, v72, 4, v97
    v_lshlrev_b32 v98, 9, v72
    v_and_b32 v72, 15, v0
    v_lshl_add_u32 v98, v72, 2, v98
    v_bfe_u32 v72, v0, 5, 1
    v_lshl_add_u32 v98, v72, 8, v98
    v_add_u32 v98, 61952, v98
    v_mov_b32 v101, 0
    v_mov_b32 v102, 0
    s_movk_i32 s13, 256
    v_mov_b32 v16, 0
    v_mov_b32 v17, 0
    v_mov_b32 v18, 0
    v_mov_b32 v19, 0
    v_mov_b32 v20, 0
    v_mov_b32 v21, 0
    v_mov_b32 v22, 0
    v_mov_b32 v23, 0
    v_mov_b32 v24, 0
    v_mov_b32 v25, 0
    v_mov_b32 v26, 0
    v_mov_b32 v27, 0
    v_mov_b32 v28, 0
    v_mov_b32 v29, 0
    v_mov_b32 v30, 0
    v_mov_b32 v31, 0
    v_mov_b32 v32, 0
    v_mov_b32 v33, 0
    v_mov_b32 v34, 0
    v_mov_b32 v35, 0
    v_mov_b32 v36, 0
    v_mov_b32 v37, 0
    v_mov_b32 v38, 0
    v_mov_b32 v39, 0
    v_mov_b32 v40, 0
    v_mov_b32 v41, 0
    v_mov_b32 v42, 0
    v_mov_b32 v43, 0
k2_dn_h:
    s_mov_b32 exec_hi, 0
    global_load_ushort v101, v99, s[14:15] sc1
    global_load_ushort v102, v99, s[14:15] offset:896 sc1
    s_mov_b64 exec, -1
    s_waitcnt vmcnt(0)
    v_max_u32 v72, v101, v102
    v_cmp_eq_u32 vcc, 0xffff, v72
    s_nop 0
    s_cmp_eq_u64 vcc, 0
    s_cbranch_scc1 k2_dn_h_ok
    s_sub_u32 s13, s13, 1
    s_cbranch_scc0 k2_dn_h
k2_dn_h_ok:
    v_lshlrev_b32 v101, 16, v101
    v_lshlrev_b32 v102, 16, v102
k2_dn_poll:
    s_movk_i32 s13, 256
    s_lshl_b32 s97, s3, 2
    v_mov_b32 v73, s97
    v_mov_b32 v74, 0
k2_dn_ld:
    s_mov_b32 exec_lo, 0x000f000f
    s_mov_b32 exec_hi, 0x000f000f
    global_load_dwordx4 v[16:19], v96, s[14:15] offset:0 sc1
    global_load_dwordx4 v[20:23], v96, s[14:15] offset:256 sc1
    global_load_dwordx4 v[24:27], v96, s[14:15] offset:512 sc1
    global_load_dwordx4 v[28:31], v96, s[14:15] offset:768 sc1
    global_load_dwordx4 v[32:35], v96, s[14:15] offset:1024 sc1
    global_load_dwordx4 v[36:39], v96, s[14:15] offset:1280 sc1
    global_load_dwordx4 v[40:43], v96, s[14:15] offset:1536 sc1
    s_mov_b64 exec, -1
    s_waitcnt vmcnt(6)
    v_mfma_f32_16x16x32_bf16 v[88:91], v[144:147], v[16:19], 0
    v_mfma_f32_16x16x32_bf16 v[92:95], v[148:151], v[16:19], 0
    v_max_u32 v72, v16, v17
    v_max3_u32 v72, v72, v18, v19
    s_waitcnt vmcnt(5)
    v_mfma_f32_16x16x32_bf16 v[88:91], v[152:155], v[20:23], v[88:91]
    v_mfma_f32_16x16x32_bf16 v[92:95], v[156:159], v[20:23], v[92:95]
    v_max3_u32 v72, v72, v20, v21
    v_max3_u32 v72, v72, v22, v23
    s_waitcnt vmcnt(4)
    v_mfma_f32_16x16x32_bf16 v[88:91], v[160:163], v[24:27], v[88:91]
    v_mfma_f32_16x16x32_bf16 v[92:95], v[164:167], v[24:27], v[92:95]
    v_max3_u32 v72, v72, v24, v25
    v_max3_u32 v72, v72, v26, v27
    s_waitcnt vmcnt(3)
    v_mfma_f32_16x16x32_bf16 v[88:91], v[168:171], v[28:31], v[88:91]
    v_mfma_f32_16x16x32_bf16 v[92:95], v[172:175], v[28:31], v[92:95]
    v_max3_u32 v72, v72, v28, v29
    v_max3_u32 v72, v72, v30, v31
    s_waitcnt vmcnt(2)
    v_mfma_f32_16x16x32_bf16 v[88:91], v[176:179], v[32:35], v[88:91]
    v_mfma_f32_16x16x32_bf16 v[92:95], v[180:183], v[32:35], v[92:95]
    v_max3_u32 v72, v72, v32, v33
    v_max3_u32 v72, v72, v34, v35
    s_waitcnt vmcnt(1)
    v_mfma_f32_16x16x32_bf16 v[88:91], v[184:187], v[36:39], v[88:91]
    v_mfma_f32_16x16x32_bf16 v[92:95], v[188:191], v[36:39], v[92:95]
    v_max3_u32 v72, v72, v36, v37
    v_max3_u32 v72, v72, v38, v39
    s_waitcnt vmcnt(0)
    v_mfma_f32_16x16x32_bf16 v[88:91], v[192:195], v[40:43], v[88:91]
    v_mfma_f32_16x16x32_bf16 v[92:95], v[196:199], v[40:43], v[92:95]
    v_max3_u32 v72, v72, v40, v41
    v_max3_u32 v72, v72, v42, v43
    v_cmp_eq_u32 vcc, -1, v72
    s_mov_b32 s97, 0
    s_cmp_eq_u64 vcc, 0
    s_cbranch_scc1 k2_dn_ok
    s_sub_u32 s13, s13, 1
    s_cbranch_scc0 k2_dn_ld
    s_mov_b32 s97, 1
k2_dn_ok:
    v_mov_b32 v72, s97
    s_mov_b32 exec_lo, 0x00030003
    s_mov_b32 exec_hi, 0x000c000c
    ds_write_b128 v97, v[88:91] offset:61952
    ds_write_b128 v97, v[92:95] offset:61984
    ds_write_b32 v73, v72 offset:60736
    s_mov_b64 exec, -1
    s_waitcnt lgkmcnt(0)
    s_barrier
    ds_read_b128 v[48:51], v74 offset:60736
    ds_read2_b32 v[72:73], v98 offset0:0 offset1:16
    ds_read2_b32 v[74:75], v98 offset0:32 offset1:48
    s_waitcnt lgkmcnt(2)
    v_max3_u32 v48, v48, v49, v50
    v_max_u32 v48, v48, v51
    s_nop 0
    v_readfirstlane_b32 s101, v48
    s_waitcnt lgkmcnt(0)
    v_pk_add_f32 v[72:73], v[72:73], v[74:75]
    s_cmp_lg_u32 s101, 0
    s_cbranch_scc1 k2_fail
    s_cmp_eq_u32 s3, 0
    s_cbranch_scc0 k2_fin
    v_add_f32 v72, v72, v73
    v_mov_b32 v73, v72
    s_nop 1
    v_permlane32_swap_b32 v72, v73
    v_add_f32 v72, v72, v73
    v_cvt_pk_bf16_f32 v72, v72, v72
    v_lshlrev_b32 v72, 16, v72
    v_mul_f32 v72, v72, v103
    v_cvt_pk_bf16_f32 v72, v72, v72
    v_lshlrev_b32 v72, 16, v72
    v_add_f32 v72, v72, v102
    v_cvt_pk_bf16_f32 v72, v72, v72
    v_lshlrev_b32 v72, 16, v72
    v_add_f32 v72, v72, v101
    v_cvt_pk_bf16_f32 v72, v72, v72
    s_mov_b32 exec_hi, 0
    global_store_short v100, v72, s[20:21]
k2_fin:
    s_cmp_lg_u32 s77, 0
    s_cbranch_scc1 k2_solo3
k2_end:
    s_endpgm
k1_wo1:
    s_sub_u32 s37, s2, 228
    s_lshl1_add_u32 s37, s37, s18
    s_lshl4_add_u32 s39, s37, 12978176
    s_lshr_b32 s38, s37, 2
    s_and_b32 s37, s37, 3
    v_min_u32 v14, 13, v2
    v_mul_u32_u24 v15, 0x1c00, v3
    v_lshl_add_u32 v14, v14, 4, v15
    v_add_u32 v15, 0xe00, v14
    s_mul_i32 s19, s38, 28672
    s_mul_i32 s26, s37, 224
    s_add_u32 s19, s19, s26
    s_add_u32 s8, s48, s19
    s_addc_u32 s9, s49, 0
    global_load_dwordx4 v[144:147], v14, s[8:9] offset:0
    global_load_dwordx4 v[148:151], v14, s[8:9] offset:896
    global_load_dwordx4 v[152:155], v14, s[8:9] offset:1792
    global_load_dwordx4 v[156:159], v14, s[8:9] offset:2688
    global_load_dwordx4 v[160:163], v15, s[8:9] offset:0
    global_load_dwordx4 v[164:167], v15, s[8:9] offset:896
    global_load_dwordx4 v[168:171], v15, s[8:9] offset:1792
    global_load_dwordx4 v[172:175], v15, s[8:9] offset:2688
    s_branch k1_wo1r
k1_wo2:
    s_movk_i32 s26, 147
    s_lshl_b32 s19, s18, 13
    s_add_u32 s19, s19, 58368
    v_min_u32 v22, 13, v2
    v_lshl_add_u32 v21, v3, 8, s19
    v_lshl_add_u32 v224, v1, 12, s39
    v_lshl_add_u32 v16, v22, 2, 0
    v_mul_u32_u24 v17, s26, v16
    v_lshrrev_b32 v17, 10, v17
    v_mad_i32_i24 v16, v17, -7, v16
    v_lshrrev_b32 v18, 2, v17
    v_and_b32 v17, 3, v17
    v_and_b32 v19, 1, v16
    v_cmp_eq_u32 vcc, 6, v16
    v_and_b32 v16, 6, v16
    s_nop 0
    v_cndmask_b32 v20, v18, v19, vcc
    v_cndmask_b32 v19, v19, v18, vcc
    v_add_u32 v16, v16, v20
    v_lshl_add_u32 v16, v16, 10, v21
    v_lshl_add_u32 v16, v19, 5, v16
    v_lshl_add_u32 v226, v17, 6, v16
    v_lshl_add_u32 v16, v22, 2, 1
    v_mul_u32_u24 v17, s26, v16
    v_lshrrev_b32 v17, 10, v17
    v_mad_i32_i24 v16, v17, -7, v16
    v_lshrrev_b32 v18, 2, v17
    v_and_b32 v17, 3, v17
    v_and_b32 v19, 1, v16
    v_cmp_eq_u32 vcc, 6, v16
    v_and_b32 v16, 6, v16
    s_nop 0
    v_cndmask_b32 v20, v18, v19, vcc
    v_cndmask_b32 v19, v19, v18, vcc
    v_add_u32 v16, v16, v20
    v_lshl_add_u32 v16, v16, 10, v21
    v_lshl_add_u32 v16, v19, 5, v16
    v_lshl_add_u32 v227, v17, 6, v16
    v_lshl_add_u32 v16, v22, 2, 2
    v_mul_u32_u24 v17, s26, v16
    v_lshrrev_b32 v17, 10, v17
    v_mad_i32_i24 v16, v17, -7, v16
    v_lshrrev_b32 v18, 2, v17
    v_and_b32 v17, 3, v17
    v_and_b32 v19, 1, v16
    v_cmp_eq_u32 vcc, 6, v16
    v_and_b32 v16, 6, v16
    s_nop 0
    v_cndmask_b32 v20, v18, v19, vcc
    v_cndmask_b32 v19, v19, v18, vcc
    v_add_u32 v16, v16, v20
    v_lshl_add_u32 v16, v16, 10, v21
    v_lshl_add_u32 v16, v19, 5, v16
    v_lshl_add_u32 v228, v17, 6, v16
    v_lshl_add_u32 v16, v22, 2, 3
    v_mul_u32_u24 v17, s26, v16
    v_lshrrev_b32 v17, 10, v17
    v_mad_i32_i24 v16, v17, -7, v16
    v_lshrrev_b32 v18, 2, v17
    v_and_b32 v17, 3, v17
    v_and_b32 v19, 1, v16
    v_cmp_eq_u32 vcc, 6, v16
    v_and_b32 v16, 6, v16
    s_nop 0
    v_cndmask_b32 v20, v18, v19, vcc
    v_cndmask_b32 v19, v19, v18, vcc
    v_add_u32 v16, v16, v20
    v_lshl_add_u32 v16, v16, 10, v21
    v_lshl_add_u32 v16, v19, 5, v16
    v_lshl_add_u32 v229, v17, 6, v16
    v_lshl_add_u32 v230, v1, 4, s19
    s_mul_i32 s19, s37, 100352
    s_lshl_b32 s26, s38, 10
    s_add_u32 s19, s19, s26
    s_add_u32 s38, s19, 13107200
    s_mov_b32 s22, 0x05040100
    s_mov_b32 s23, 0x07060302
    s_branch k1_wo2r
k1_wo3:
    v_lshl_add_u32 v231, v1, 4, s38
    v_perm_b32 v176, v148, v144, s22
    v_perm_b32 v177, v156, v152, s22
    v_perm_b32 v178, v164, v160, s22
    v_perm_b32 v179, v172, v168, s22
    ds_write_b128 v226, v[176:179] offset:0
    v_perm_b32 v180, v148, v144, s23
    v_perm_b32 v181, v156, v152, s23
    v_perm_b32 v182, v164, v160, s23
    v_perm_b32 v183, v172, v168, s23
    ds_write_b128 v226, v[180:183] offset:16
    v_perm_b32 v184, v149, v145, s22
    v_perm_b32 v185, v157, v153, s22
    v_perm_b32 v186, v165, v161, s22
    v_perm_b32 v187, v173, v169, s22
    ds_write_b128 v227, v[184:187] offset:0
    v_perm_b32 v188, v149, v145, s23
    v_perm_b32 v189, v157, v153, s23
    v_perm_b32 v190, v165, v161, s23
    v_perm_b32 v191, v173, v169, s23
    ds_write_b128 v227, v[188:191] offset:16
    v_perm_b32 v192, v150, v146, s22
    v_perm_b32 v193, v158, v154, s22
    v_perm_b32 v194, v166, v162, s22
    v_perm_b32 v195, v174, v170, s22
    ds_write_b128 v228, v[192:195] offset:0
    v_perm_b32 v196, v150, v146, s23
    v_perm_b32 v197, v158, v154, s23
    v_perm_b32 v198, v166, v162, s23
    v_perm_b32 v199, v174, v170, s23
    ds_write_b128 v228, v[196:199] offset:16
    v_perm_b32 v200, v151, v147, s22
    v_perm_b32 v201, v159, v155, s22
    v_perm_b32 v202, v167, v163, s22
    v_perm_b32 v203, v175, v171, s22
    ds_write_b128 v229, v[200:203] offset:0
    v_perm_b32 v204, v151, v147, s23
    v_perm_b32 v205, v159, v155, s23
    v_perm_b32 v206, v167, v163, s23
    v_perm_b32 v207, v175, v171, s23
    ds_write_b128 v229, v[204:207] offset:16
    s_waitcnt lgkmcnt(0)
    ds_read_b128 v[144:147], v230 offset:0
    ds_read_b128 v[148:151], v230 offset:1024
    ds_read_b128 v[152:155], v230 offset:2048
    ds_read_b128 v[156:159], v230 offset:3072
    ds_read_b128 v[160:163], v230 offset:4096
    ds_read_b128 v[164:167], v230 offset:5120
    ds_read_b128 v[168:171], v230 offset:6144
    s_waitcnt lgkmcnt(6)
    global_store_dwordx4 v231, v[144:147], s[14:15] sc1
    v_add_u32 v231, 0x3800, v231
    s_waitcnt lgkmcnt(5)
    global_store_dwordx4 v231, v[148:151], s[14:15] sc1
    v_add_u32 v231, 0x3800, v231
    s_waitcnt lgkmcnt(4)
    global_store_dwordx4 v231, v[152:155], s[14:15] sc1
    v_add_u32 v231, 0x3800, v231
    s_waitcnt lgkmcnt(3)
    global_store_dwordx4 v231, v[156:159], s[14:15] sc1
    v_add_u32 v231, 0x3800, v231
    s_waitcnt lgkmcnt(2)
    global_store_dwordx4 v231, v[160:163], s[14:15] sc1
    v_add_u32 v231, 0x3800, v231
    s_waitcnt lgkmcnt(1)
    global_store_dwordx4 v231, v[164:167], s[14:15] sc1
    v_add_u32 v231, 0x3800, v231
    s_waitcnt lgkmcnt(0)
    global_store_dwordx4 v231, v[168:171], s[14:15] sc1
    s_mov_b64 exec, 0
    s_branch k1_fill7
k2_req:
    s_cmp_eq_u32 s9, 0
    s_cselect_b32 s73, 4, 0
    s_cbranch_scc1 k2_goq
    s_sub_u32 s9, s9, 1
    global_load_dwordx4 v[128:131], v253, s[14:15] offset:0 sc1
    global_load_dwordx4 v[132:135], v253, s[14:15] offset:1024 sc1
    global_load_dwordx4 v[136:139], v253, s[14:15] offset:2048 sc1
    global_load_dwordx4 v[140:143], v253, s[14:15] offset:3072 sc1
    s_memrealtime s[96:97]
    s_mov_b64 exec, -1
    s_waitcnt vmcnt(0) lgkmcnt(0)
    s_and_b32 s22, s9, 7
    s_cbranch_scc1 k2_chkq
    s_mov_b64 s[82:83], s[96:97]
    global_load_dwordx4 v[156:159], v254, s[14:15] offset:0 sc1
    global_load_dwordx4 v[160:163], v254, s[14:15] offset:1024 sc1
    global_load_dwordx4 v[180:183], v254, s[14:15] offset:2048 sc1
    global_load_dwordx4 v[184:187], v254, s[14:15] offset:3072 sc1
    global_load_dwordx2 v[144:145], v252, s[14:15] offset:2048 sc1
    global_load_dwordx4 v[148:151], v252, s[14:15] offset:0 sc1
    global_load_dwordx4 v[152:155], v252, s[14:15] offset:1024 sc1
    s_waitcnt vmcnt(0)
    s_branch k2_chkq
k2_repoll:
    s_memrealtime s[82:83]
    s_cmp_eq_u32 s9, 0
    s_cselect_b32 s73, 4, 0
    s_cbranch_scc1 k2_go
    s_sub_u32 s9, s9, 1
    s_waitcnt lgkmcnt(0)
    global_load_dwordx4 v[156:159], v254, s[14:15] offset:0 sc1
    global_load_dwordx4 v[160:163], v254, s[14:15] offset:1024 sc1
    global_load_dwordx4 v[180:183], v254, s[14:15] offset:2048 sc1
    global_load_dwordx4 v[184:187], v254, s[14:15] offset:3072 sc1
    global_load_dwordx2 v[144:145], v252, s[14:15] offset:2048 sc1
    global_load_dwordx4 v[148:151], v252, s[14:15] offset:0 sc1
    global_load_dwordx4 v[152:155], v252, s[14:15] offset:1024 sc1
    s_branch k2_chk
k2_ffb:
    s_memrealtime s[82:83]
    s_cmp_eq_u32 s9, 0
    s_cselect_b32 s73, 4, 0
    s_cbranch_scc1 k2_ffc
    s_sub_u32 s9, s9, 1
    global_load_dwordx2 v[14:15], v6, s[14:15] sc1
    s_waitcnt vmcnt(0) lgkmcnt(0)
    s_branch k2_ffa
k2_nan:
    s_cmp_eq_u32 s78, 0
    s_cbranch_scc1 k2_nan_ok
    s_sub_u32 s78, s78, 1
    s_branch k2_again
k2_fail:
    s_load_dwordx2 s[96:97], s[0:1], 88
    v_mov_b32 v14, 0
    v_mov_b32 v15, 1
    s_waitcnt vmcnt(0) lgkmcnt(0)
    s_barrier
    s_cmp_lg_u32 s3, 0
    s_cbranch_scc1 k2_fail1
    s_mov_b64 exec, 1
    global_atomic_add v15, v14, v15, s[96:97] sc0 sc1
    s_waitcnt vmcnt(0)
    ds_write_b32 v14, v15
    s_mov_b64 exec, -1
    s_waitcnt lgkmcnt(0)
k2_fail1:
    s_barrier
    ds_read_b32 v15, v14
    s_waitcnt lgkmcnt(0)
    v_readfirstlane_b32 s96, v15
    s_barrier
    s_cmp_lg_u32 s96, 0
    s_cbranch_scc1 k2_end
    s_mov_b32 s77, 0x4000000
    s_mov_b32 s100, 0
    s_mov_b32 s2, 0
    s_branch k1_entry
k2_solo1:
    s_waitcnt lgkmcnt(0)
    s_mov_b64 exec, s[66:67]
    buffer_store_dwordx4 a[208:211], v255, s[4:7], s68 offen offset:0 sc1
    buffer_store_dwordx4 a[212:215], v255, s[4:7], s68 offen offset:512 sc1
    buffer_store_dwordx4 a[216:219], v255, s[4:7], s69 offen offset:0 sc1
    buffer_store_dwordx4 a[220:223], v255, s[4:7], s69 offen offset:512 sc1
    buffer_store_dwordx4 a[224:227], v255, s[4:7], s70 offen offset:0 sc1
    buffer_store_dwordx4 a[228:231], v255, s[4:7], s70 offen offset:512 sc1
    buffer_store_dwordx4 a[232:235], v255, s[4:7], s71 offen offset:0 sc1
    buffer_store_dwordx4 a[236:239], v255, s[4:7], s71 offen offset:512 sc1
    s_mov_b64 exec, s[64:65]
    global_store_dwordx4 v251, a[204:207], s[14:15] sc1
    s_mov_b64 exec, -1
    s_waitcnt vmcnt(0)
    s_barrier
    s_add_u32 s2, s2, 1
    s_cmp_lt_u32 s2, 256
    s_cbranch_scc1 k1_entry
    s_branch k2_solo4
k2_solo2:
    s_cmp_eq_u32 s100, 2
    s_cbranch_scc1 k2_solo2r
k2_solo3:
    s_mov_b64 exec, -1
    s_waitcnt vmcnt(0) lgkmcnt(0)
    s_barrier
    s_add_u32 s2, s2, 1
    s_cmp_lt_u32 s2, 256
    s_cbranch_scc1 k2_again
k2_solo4:
    s_mov_b32 s2, 0
    s_add_u32 s100, s100, 1
    s_cmp_eq_u32 s100, 3
    s_cbranch_scc1 k2_end
k2_again:
    v_and_b32 v3, 63, v0
    v_lshrrev_b32 v4, 6, v0
    s_nop 0
    v_readfirstlane_b32 s3, v4
    s_waitcnt vmcnt(0) lgkmcnt(0)
    s_cmp_lg_u32 s77, 0
    s_cselect_b64 s[80:81], 0, s[80:81]
    s_mov_b64 s[64:65], 0
    s_mov_b64 s[66:67], 0
    s_and_b32 s96, s2, 7
    s_and_b32 s28, s2, 0xe0
    s_lshl2_add_u32 s28, s96, s28
    s_lshl_b32 s96, s96, 12
    v_lshl_add_u32 v252, v3, 4, s96
    s_bfe_u32 s96, s2, 0x10003
    s_lshl1_add_u32 s96, s3, s96
    s_lshl_b32 s96, s96, 15
    s_add_u32 s96, s96, 12582912
    v_add_u32 v254, s96, v252
    v_add_u32 v252, 12976128, v252
    s_bfe_u32 s96, s2, 0x20003
    s_add_u32 s28, s28, s96
    s_lshl2_add_u32 s96, s28, s3
    s_lshl_b32 s96, s96, 12
    v_lshl_add_u32 v253, v3, 4, s96
    s_branch k2_restart
k2_slow:
    s_waitcnt vmcnt(0) lgkmcnt(0)
    s_bitcmp1_b32 s96, 2
    s_cbranch_scc1 k2_fail
    s_bitcmp0_b32 s96, 1
    s_cbranch_scc1 k2_slow1
    s_cmp_eq_u32 s78, 0
    s_cbranch_scc1 k2_slow1
    s_sub_u32 s78, s78, 1
    s_branch k2_again
k2_slow1:
    s_mov_b32 s8, -1
    s_movk_i32 s9, 300
    v_add_u32 v14, 13018304, v1
k2_slow2:
    global_load_dwordx2 v[72:73], v14, s[14:15] sc1
    global_load_dwordx2 v[74:75], v14, s[14:15] offset:1024 sc1
    s_waitcnt vmcnt(0) lgkmcnt(0)
    v_cmpx_le_u64 vcc, s[80:81], v[72:73]
    v_cmpx_ge_u64 vcc, s[82:83], v[72:73]
    v_cmpx_le_u64 vcc, s[80:81], v[74:75]
    v_cmpx_ge_u64 vcc, s[82:83], v[74:75]
    s_nop 0
    s_cmp_eq_u64 exec, -1
    s_mov_b64 exec, -1
    s_cbranch_scc1 k2_slow3
    s_memrealtime s[82:83]
    s_sub_u32 s9, s9, 1
    s_cbranch_scc0 k2_slow2
    s_mov_b32 s73, 4
k2_slow3:
    s_add_u32 s96, s3, 0
    s_and_b32 s96, s96, 3
    s_lshl2_add_u32 s96, s28, s96
    s_lshl_b32 s96, s96, 12
    buffer_load_dwordx2 v[80:81], v1, s[4:7], s96 offen offset:0 sc1
    buffer_load_dwordx2 v[82:83], v1, s[4:7], s96 offen offset:2048 sc1
    buffer_load_dwordx2 v[84:85], v1, s[4:7], s96 offen offset:1024 sc1
    buffer_load_dwordx2 v[86:87], v1, s[4:7], s96 offen offset:3072 sc1
    s_add_u32 s96, s3, 1
    s_and_b32 s96, s96, 3
    s_lshl2_add_u32 s96, s28, s96
    s_lshl_b32 s96, s96, 12
    buffer_load_dwordx2 v[88:89], v1, s[4:7], s96 offen offset:0 sc1
    buffer_load_dwordx2 v[90:91], v1, s[4:7], s96 offen offset:2048 sc1
    buffer_load_dwordx2 v[92:93], v1, s[4:7], s96 offen offset:1024 sc1
    buffer_load_dwordx2 v[94:95], v1, s[4:7], s96 offen offset:3072 sc1
    s_add_u32 s96, s3, 2
    s_and_b32 s96, s96, 3
    s_lshl2_add_u32 s96, s28, s96
    s_lshl_b32 s96, s96, 12
    buffer_load_dwordx2 v[96:97], v1, s[4:7], s96 offen offset:0 sc1
    buffer_load_dwordx2 v[98:99], v1, s[4:7], s96 offen offset:2048 sc1
    buffer_load_dwordx2 v[100:101], v1, s[4:7], s96 offen offset:1024 sc1
    buffer_load_dwordx2 v[102:103], v1, s[4:7], s96 offen offset:3072 sc1
    s_add_u32 s96, s3, 3
    s_and_b32 s96, s96, 3
    s_lshl2_add_u32 s96, s28, s96
    s_lshl_b32 s96, s96, 12
    buffer_load_dwordx2 v[104:105], v1, s[4:7], s96 offen offset:0 sc1
    buffer_load_dwordx2 v[106:107], v1, s[4:7], s96 offen offset:2048 sc1
    buffer_load_dwordx2 v[108:109], v1, s[4:7], s96 offen offset:1024 sc1
    buffer_load_dwordx2 v[110:111], v1, s[4:7], s96 offen offset:3072 sc1
    s_mov_b32 s96, 0
    v_mov_b32 v152, 0xff800000
    v_mov_b32 v153, 0xff800000
    v_mov_b32 v154, 0xff800000
    v_mov_b32 v155, 0xff800000
    s_waitcnt vmcnt(0)
    s_mov_b32 exec_lo, 0
    v_mov_b32 v86, 0
    v_mov_b32 v87, 0
    v_mov_b32 v94, 0
    v_mov_b32 v95, 0
    v_mov_b32 v102, 0
    v_mov_b32 v103, 0
    v_mov_b32 v110, 0
    v_mov_b32 v111, 0
    s_mov_b64 exec, -1
k2_sl_max:
    s_add_u32 s11, s96, s10
    buffer_load_dwordx4 v[156:159], v1, s[4:7], s11 offen sc1
    buffer_load_dwordx4 v[160:163], v1, s[4:7], s11 offen offset:1024 sc1
    s_waitcnt vmcnt(0)
    v_mfma_f32_32x32x16_bf16 v[112:127], v[156:159], v[80:83], 0
    v_mfma_f32_32x32x16_bf16 v[112:127], v[160:163], v[84:87], v[112:127]
    s_nop 11
    v_max3_f32 v152, v152, v112, v113
    v_max3_f32 v152, v152, v114, v115
    v_max3_f32 v152, v152, v116, v117
    v_max3_f32 v152, v152, v118, v119
    v_max3_f32 v152, v152, v120, v121
    v_max3_f32 v152, v152, v122, v123
    v_max3_f32 v152, v152, v124, v125
    v_max3_f32 v152, v152, v126, v127
    v_mfma_f32_32x32x16_bf16 v[128:143], v[156:159], v[88:91], 0
    v_mfma_f32_32x32x16_bf16 v[128:143], v[160:163], v[92:95], v[128:143]
    s_nop 11
    v_max3_f32 v153, v153, v128, v129
    v_max3_f32 v153, v153, v130, v131
    v_max3_f32 v153, v153, v132, v133
    v_max3_f32 v153, v153, v134, v135
    v_max3_f32 v153, v153, v136, v137
    v_max3_f32 v153, v153, v138, v139
    v_max3_f32 v153, v153, v140, v141
    v_max3_f32 v153, v153, v142, v143
    v_mfma_f32_32x32x16_bf16 v[112:127], v[156:159], v[96:99], 0
    v_mfma_f32_32x32x16_bf16 v[112:127], v[160:163], v[100:103], v[112:127]
    s_nop 11
    v_max3_f32 v154, v154, v112, v113
    v_max3_f32 v154, v154, v114, v115
    v_max3_f32 v154, v154, v116, v117
    v_max3_f32 v154, v154, v118, v119
    v_max3_f32 v154, v154, v120, v121
    v_max3_f32 v154, v154, v122, v123
    v_max3_f32 v154, v154, v124, v125
    v_max3_f32 v154, v154, v126, v127
    v_mfma_f32_32x32x16_bf16 v[128:143], v[156:159], v[104:107], 0
    v_mfma_f32_32x32x16_bf16 v[128:143], v[160:163], v[108:111], v[128:143]
    s_nop 11
    v_max3_f32 v155, v155, v128, v129
    v_max3_f32 v155, v155, v130, v131
    v_max3_f32 v155, v155, v132, v133
    v_max3_f32 v155, v155, v134, v135
    v_max3_f32 v155, v155, v136, v137
    v_max3_f32 v155, v155, v138, v139
    v_max3_f32 v155, v155, v140, v141
    v_max3_f32 v155, v155, v142, v143
    s_add_u32 s96, s96, 4096
    s_cmp_lt_u32 s96, 65536
    s_cbranch_scc1 k2_sl_max
    v_and_b32 v14, 31, v0
    v_lshlrev_b32 v14, 4, v14
    v_mov_b32 v15, v152
    s_nop 1
    v_permlane32_swap_b32 v152, v15
    v_max_f32 v152, v152, v15
    s_add_u32 s96, s3, 0
    s_and_b32 s96, s96, 3
    s_lshl_b32 s96, s96, 9
    v_add_u32 v144, s96, v14
    v_add_u32 v15, s22, v144
    ds_write_b32 v15, v152 offset:58624
    v_mov_b32 v15, v153
    s_nop 1
    v_permlane32_swap_b32 v153, v15
    v_max_f32 v153, v153, v15
    s_add_u32 s96, s3, 1
    s_and_b32 s96, s96, 3
    s_lshl_b32 s96, s96, 9
    v_add_u32 v145, s96, v14
    v_add_u32 v15, s22, v145
    ds_write_b32 v15, v153 offset:58624
    v_mov_b32 v15, v154
    s_nop 1
    v_permlane32_swap_b32 v154, v15
    v_max_f32 v154, v154, v15
    s_add_u32 s96, s3, 2
    s_and_b32 s96, s96, 3
    s_lshl_b32 s96, s96, 9
    v_add_u32 v146, s96, v14
    v_add_u32 v15, s22, v146
    ds_write_b32 v15, v154 offset:58624
    v_mov_b32 v15, v155
    s_nop 1
    v_permlane32_swap_b32 v155, v15
    v_max_f32 v155, v155, v15
    s_add_u32 s96, s3, 3
    s_and_b32 s96, s96, 3
    s_lshl_b32 s96, s96, 9
    v_add_u32 v147, s96, v14
    v_add_u32 v15, s22, v147
    ds_write_b32 v15, v155 offset:58624
    s_waitcnt lgkmcnt(0)
    s_barrier
    ds_read_b128 v[112:115], v144 offset:58624
    ds_read_b128 v[116:119], v145 offset:58624
    ds_read_b128 v[120:123], v146 offset:58624
    ds_read_b128 v[124:127], v147 offset:58624
    s_waitcnt lgkmcnt(0)
    s_mov_b32 s12, 0x427fff00
    v_max3_f32 v152, v112, v113, v114
    v_max_f32 v152, v152, v115
    v_max3_f32 v153, v116, v117, v118
    v_max_f32 v153, v153, v119
    v_max3_f32 v154, v120, v121, v122
    v_max_f32 v154, v154, v123
    v_max3_f32 v155, v124, v125, v126
    v_max_f32 v155, v155, v127
    v_mov_b32 v16, 0
    v_mov_b32 v17, 0
    v_mov_b32 v18, 0
    v_mov_b32 v19, 0
    v_mov_b32 v20, 0
    v_mov_b32 v21, 0
    v_mov_b32 v22, 0
    v_mov_b32 v23, 0
    v_mov_b32 v24, 0
    v_mov_b32 v25, 0
    v_mov_b32 v26, 0
    v_mov_b32 v27, 0
    v_mov_b32 v28, 0
    v_mov_b32 v29, 0
    v_mov_b32 v30, 0
    v_mov_b32 v31, 0
    v_mov_b32 v32, 0
    v_mov_b32 v33, 0
    v_mov_b32 v34, 0
    v_mov_b32 v35, 0
    v_mov_b32 v36, 0
    v_mov_b32 v37, 0
    v_mov_b32 v38, 0
    v_mov_b32 v39, 0
    v_mov_b32 v40, 0
    v_mov_b32 v41, 0
    v_mov_b32 v42, 0
    v_mov_b32 v43, 0
    v_mov_b32 v44, 0
    v_mov_b32 v45, 0
    v_mov_b32 v46, 0
    v_mov_b32 v47, 0
    v_mov_b32 v48, 0
    v_mov_b32 v49, 0
    v_mov_b32 v50, 0
    v_mov_b32 v51, 0
    v_mov_b32 v52, 0
    v_mov_b32 v53, 0
    v_mov_b32 v54, 0
    v_mov_b32 v55, 0
    v_mov_b32 v56, 0
    v_mov_b32 v57, 0
    v_mov_b32 v58, 0
    v_mov_b32 v59, 0
    v_mov_b32 v60, 0
    v_mov_b32 v61, 0
    v_mov_b32 v62, 0
    v_mov_b32 v63, 0
    v_mov_b32 v64, 0
    v_mov_b32 v65, 0
    v_mov_b32 v66, 0
    v_mov_b32 v67, 0
    v_mov_b32 v68, 0
    v_mov_b32 v69, 0
    v_mov_b32 v70, 0
    v_mov_b32 v71, 0
    v_mov_b32 v72, 0
    v_mov_b32 v73, 0
    v_mov_b32 v74, 0
    v_mov_b32 v75, 0
    v_mov_b32 v76, 0
    v_mov_b32 v77, 0
    v_mov_b32 v78, 0
    v_mov_b32 v79, 0
    s_mov_b32 s96, 0
k2_sl_pv:
    s_add_u32 s11, s96, s10
    s_sub_u32 s13, s11, 12582912
    s_lshr_b32 s13, s13, 1
    s_add_u32 s13, s13, 12845056
    buffer_load_dwordx4 v[156:159], v1, s[4:7], s11 offen sc1
    buffer_load_dwordx4 v[160:163], v1, s[4:7], s11 offen offset:1024 sc1
    buffer_load_dwordx4 v[180:183], v1, s[4:7], s13 offen sc1
    buffer_load_dwordx4 v[184:187], v1, s[4:7], s13 offen offset:1024 sc1
    s_waitcnt vmcnt(0)
    v_mfma_f32_32x32x16_bf16 v[112:127], v[156:159], v[80:83], 0
    v_mfma_f32_32x32x16_bf16 v[112:127], v[160:163], v[84:87], v[112:127]
    s_nop 11
    v_sub_f32 v112, v112, v152
    v_sub_f32 v113, v113, v152
    v_sub_f32 v114, v114, v152
    v_sub_f32 v115, v115, v152
    v_sub_f32 v116, v116, v152
    v_sub_f32 v117, v117, v152
    v_sub_f32 v118, v118, v152
    v_sub_f32 v119, v119, v152
    v_sub_f32 v120, v120, v152
    v_sub_f32 v121, v121, v152
    v_sub_f32 v122, v122, v152
    v_sub_f32 v123, v123, v152
    v_sub_f32 v124, v124, v152
    v_sub_f32 v125, v125, v152
    v_sub_f32 v126, v126, v152
    v_sub_f32 v127, v127, v152
    v_mul_f32 v112, s12, v112
    v_mul_f32 v113, s12, v113
    v_mul_f32 v114, s12, v114
    v_mul_f32 v115, s12, v115
    v_mul_f32 v116, s12, v116
    v_mul_f32 v117, s12, v117
    v_mul_f32 v118, s12, v118
    v_mul_f32 v119, s12, v119
    v_mul_f32 v120, s12, v120
    v_mul_f32 v121, s12, v121
    v_mul_f32 v122, s12, v122
    v_mul_f32 v123, s12, v123
    v_mul_f32 v124, s12, v124
    v_mul_f32 v125, s12, v125
    v_mul_f32 v126, s12, v126
    v_mul_f32 v127, s12, v127
    v_exp_f32 v112, v112
    v_exp_f32 v113, v113
    v_exp_f32 v114, v114
    v_exp_f32 v115, v115
    v_exp_f32 v116, v116
    v_exp_f32 v117, v117
    v_exp_f32 v118, v118
    v_exp_f32 v119, v119
    v_exp_f32 v120, v120
    v_exp_f32 v121, v121
    v_exp_f32 v122, v122
    v_exp_f32 v123, v123
    v_exp_f32 v124, v124
    v_exp_f32 v125, v125
    v_exp_f32 v126, v126
    v_exp_f32 v127, v127
    v_cvt_pk_bf16_f32 v144, v112, v113
    v_cvt_pk_bf16_f32 v145, v114, v115
    v_cvt_pk_bf16_f32 v146, v116, v117
    v_cvt_pk_bf16_f32 v147, v118, v119
    v_cvt_pk_bf16_f32 v148, v120, v121
    v_cvt_pk_bf16_f32 v149, v122, v123
    v_cvt_pk_bf16_f32 v150, v124, v125
    v_cvt_pk_bf16_f32 v151, v126, v127
    v_mfma_f32_32x32x16_bf16 v[16:31], v[180:183], v[144:147], v[16:31]
    s_nop 0
    v_mfma_f32_32x32x16_bf16 v[16:31], v[184:187], v[148:151], v[16:31]
    v_mfma_f32_32x32x16_bf16 v[128:143], v[156:159], v[88:91], 0
    v_mfma_f32_32x32x16_bf16 v[128:143], v[160:163], v[92:95], v[128:143]
    s_nop 11
    v_sub_f32 v128, v128, v153
    v_sub_f32 v129, v129, v153
    v_sub_f32 v130, v130, v153
    v_sub_f32 v131, v131, v153
    v_sub_f32 v132, v132, v153
    v_sub_f32 v133, v133, v153
    v_sub_f32 v134, v134, v153
    v_sub_f32 v135, v135, v153
    v_sub_f32 v136, v136, v153
    v_sub_f32 v137, v137, v153
    v_sub_f32 v138, v138, v153
    v_sub_f32 v139, v139, v153
    v_sub_f32 v140, v140, v153
    v_sub_f32 v141, v141, v153
    v_sub_f32 v142, v142, v153
    v_sub_f32 v143, v143, v153
    v_mul_f32 v128, s12, v128
    v_mul_f32 v129, s12, v129
    v_mul_f32 v130, s12, v130
    v_mul_f32 v131, s12, v131
    v_mul_f32 v132, s12, v132
    v_mul_f32 v133, s12, v133
    v_mul_f32 v134, s12, v134
    v_mul_f32 v135, s12, v135
    v_mul_f32 v136, s12, v136
    v_mul_f32 v137, s12, v137
    v_mul_f32 v138, s12, v138
    v_mul_f32 v139, s12, v139
    v_mul_f32 v140, s12, v140
    v_mul_f32 v141, s12, v141
    v_mul_f32 v142, s12, v142
    v_mul_f32 v143, s12, v143
    v_exp_f32 v128, v128
    v_exp_f32 v129, v129
    v_exp_f32 v130, v130
    v_exp_f32 v131, v131
    v_exp_f32 v132, v132
    v_exp_f32 v133, v133
    v_exp_f32 v134, v134
    v_exp_f32 v135, v135
    v_exp_f32 v136, v136
    v_exp_f32 v137, v137
    v_exp_f32 v138, v138
    v_exp_f32 v139, v139
    v_exp_f32 v140, v140
    v_exp_f32 v141, v141
    v_exp_f32 v142, v142
    v_exp_f32 v143, v143
    v_cvt_pk_bf16_f32 v144, v128, v129
    v_cvt_pk_bf16_f32 v145, v130, v131
    v_cvt_pk_bf16_f32 v146, v132, v133
    v_cvt_pk_bf16_f32 v147, v134, v135
    v_cvt_pk_bf16_f32 v148, v136, v137
    v_cvt_pk_bf16_f32 v149, v138, v139
    v_cvt_pk_bf16_f32 v150, v140, v141
    v_cvt_pk_bf16_f32 v151, v142, v143
    v_mfma_f32_32x32x16_bf16 v[32:47], v[180:183], v[144:147], v[32:47]
    s_nop 0
    v_mfma_f32_32x32x16_bf16 v[32:47], v[184:187], v[148:151], v[32:47]
    v_mfma_f32_32x32x16_bf16 v[112:127], v[156:159], v[96:99], 0
    v_mfma_f32_32x32x16_bf16 v[112:127], v[160:163], v[100:103], v[112:127]
    s_nop 11
    v_sub_f32 v112, v112, v154
    v_sub_f32 v113, v113, v154
    v_sub_f32 v114, v114, v154
    v_sub_f32 v115, v115, v154
    v_sub_f32 v116, v116, v154
    v_sub_f32 v117, v117, v154
    v_sub_f32 v118, v118, v154
    v_sub_f32 v119, v119, v154
    v_sub_f32 v120, v120, v154
    v_sub_f32 v121, v121, v154
    v_sub_f32 v122, v122, v154
    v_sub_f32 v123, v123, v154
    v_sub_f32 v124, v124, v154
    v_sub_f32 v125, v125, v154
    v_sub_f32 v126, v126, v154
    v_sub_f32 v127, v127, v154
    v_mul_f32 v112, s12, v112
    v_mul_f32 v113, s12, v113
    v_mul_f32 v114, s12, v114
    v_mul_f32 v115, s12, v115
    v_mul_f32 v116, s12, v116
    v_mul_f32 v117, s12, v117
    v_mul_f32 v118, s12, v118
    v_mul_f32 v119, s12, v119
    v_mul_f32 v120, s12, v120
    v_mul_f32 v121, s12, v121
    v_mul_f32 v122, s12, v122
    v_mul_f32 v123, s12, v123
    v_mul_f32 v124, s12, v124
    v_mul_f32 v125, s12, v125
    v_mul_f32 v126, s12, v126
    v_mul_f32 v127, s12, v127
    v_exp_f32 v112, v112
    v_exp_f32 v113, v113
    v_exp_f32 v114, v114
    v_exp_f32 v115, v115
    v_exp_f32 v116, v116
    v_exp_f32 v117, v117
    v_exp_f32 v118, v118
    v_exp_f32 v119, v119
    v_exp_f32 v120, v120
    v_exp_f32 v121, v121
    v_exp_f32 v122, v122
    v_exp_f32 v123, v123
    v_exp_f32 v124, v124
    v_exp_f32 v125, v125
    v_exp_f32 v126, v126
    v_exp_f32 v127, v127
    v_cvt_pk_bf16_f32 v144, v112, v113
    v_cvt_pk_bf16_f32 v145, v114, v115
    v_cvt_pk_bf16_f32 v146, v116, v117
    v_cvt_pk_bf16_f32 v147, v118, v119
    v_cvt_pk_bf16_f32 v148, v120, v121
    v_cvt_pk_bf16_f32 v149, v122, v123
    v_cvt_pk_bf16_f32 v150, v124, v125
    v_cvt_pk_bf16_f32 v151, v126, v127
    v_mfma_f32_32x32x16_bf16 v[48:63], v[180:183], v[144:147], v[48:63]
    s_nop 0
    v_mfma_f32_32x32x16_bf16 v[48:63], v[184:187], v[148:151], v[48:63]
    v_mfma_f32_32x32x16_bf16 v[128:143], v[156:159], v[104:107], 0
    v_mfma_f32_32x32x16_bf16 v[128:143], v[160:163], v[108:111], v[128:143]
    s_nop 11
    v_sub_f32 v128, v128, v155
    v_sub_f32 v129, v129, v155
    v_sub_f32 v130, v130, v155
    v_sub_f32 v131, v131, v155
    v_sub_f32 v132, v132, v155
    v_sub_f32 v133, v133, v155
    v_sub_f32 v134, v134, v155
    v_sub_f32 v135, v135, v155
    v_sub_f32 v136, v136, v155
    v_sub_f32 v137, v137, v155
    v_sub_f32 v138, v138, v155
    v_sub_f32 v139, v139, v155
    v_sub_f32 v140, v140, v155
    v_sub_f32 v141, v141, v155
    v_sub_f32 v142, v142, v155
    v_sub_f32 v143, v143, v155
    v_mul_f32 v128, s12, v128
    v_mul_f32 v129, s12, v129
    v_mul_f32 v130, s12, v130
    v_mul_f32 v131, s12, v131
    v_mul_f32 v132, s12, v132
    v_mul_f32 v133, s12, v133
    v_mul_f32 v134, s12, v134
    v_mul_f32 v135, s12, v135
    v_mul_f32 v136, s12, v136
    v_mul_f32 v137, s12, v137
    v_mul_f32 v138, s12, v138
    v_mul_f32 v139, s12, v139
    v_mul_f32 v140, s12, v140
    v_mul_f32 v141, s12, v141
    v_mul_f32 v142, s12, v142
    v_mul_f32 v143, s12, v143
    v_exp_f32 v128, v128
    v_exp_f32 v129, v129
    v_exp_f32 v130, v130
    v_exp_f32 v131, v131
    v_exp_f32 v132, v132
    v_exp_f32 v133, v133
    v_exp_f32 v134, v134
    v_exp_f32 v135, v135
    v_exp_f32 v136, v136
    v_exp_f32 v137, v137
    v_exp_f32 v138, v138
    v_exp_f32 v139, v139
    v_exp_f32 v140, v140
    v_exp_f32 v141, v141
    v_exp_f32 v142, v142
    v_exp_f32 v143, v143
    v_cvt_pk_bf16_f32 v144, v128, v129
    v_cvt_pk_bf16_f32 v145, v130, v131
    v_cvt_pk_bf16_f32 v146, v132, v133
    v_cvt_pk_bf16_f32 v147, v134, v135
    v_cvt_pk_bf16_f32 v148, v136, v137
    v_cvt_pk_bf16_f32 v149, v138, v139
    v_cvt_pk_bf16_f32 v150, v140, v141
    v_cvt_pk_bf16_f32 v151, v142, v143
    v_mfma_f32_32x32x16_bf16 v[64:79], v[180:183], v[144:147], v[64:79]
    s_nop 0
    v_mfma_f32_32x32x16_bf16 v[64:79], v[184:187], v[148:151], v[64:79]
    s_add_u32 s96, s96, 4096
    s_cmp_lt_u32 s96, 65536
    s_cbranch_scc1 k2_sl_pv
    ds_write_b128 v8, v[32:35] offset:0
    ds_write_b128 v8, v[36:39] offset:1024
    ds_write_b128 v8, v[40:43] offset:2048
    ds_write_b128 v8, v[44:47] offset:3072
    ds_write_b128 v9, v[48:51] offset:0
    ds_write_b128 v9, v[52:55] offset:1024
    ds_write_b128 v9, v[56:59] offset:2048
    ds_write_b128 v9, v[60:63] offset:3072
    s_nop 0
    ds_write_b128 v10, v[64:67] offset:0
    ds_write_b128 v10, v[68:71] offset:1024
    ds_write_b128 v10, v[72:75] offset:2048
    ds_write_b128 v10, v[76:79] offset:3072
    global_load_dwordx4 v[96:99], v7, s[16:17]
    global_load_dwordx3 v[100:102], v7, s[16:17] offset:16
    global_load_dwordx4 v[104:107], v13, s[18:19]
    global_load_dwordx3 v[108:110], v13, s[18:19] offset:16
    s_add_u32 s12, s80, 800
    s_addc_u32 s13, s81, 0
    s_waitcnt vmcnt(0)
    s_branch k2_comb
.section .rodata,"a"
.p2align 6
.amdhsa_kernel sequential_preLN__grouped_kv_mqa__moe_arch_mod__prompt_kernel
  .amdhsa_next_free_vgpr 512
  .amdhsa_next_free_sgpr 102
  .amdhsa_accum_offset 256
  .amdhsa_group_segment_fixed_size 0
  .amdhsa_kernarg_size 104
  .amdhsa_user_sgpr_count 2
  .amdhsa_user_sgpr_kernarg_segment_ptr 1
  .amdhsa_system_sgpr_workgroup_id_x 1
.end_amdhsa_kernel
```
